```python
import torch

def _softmax(x, axis=-1):
    return torch.softmax(x, dim=axis)
def _gelu(x):
    return torch.nn.functional.gelu(x, approximate="tanh")
def _silu(x):
    return torch.nn.functional.silu(x)
def _sigmoid(x):
    return torch.sigmoid(x)
def _layernorm(x, axis=-1, eps=1e-5):
    m = x.mean(dim=axis, keepdim=True)
    v = x.var(dim=axis, keepdim=True, unbiased=False)
    return (x - m) / torch.sqrt(v + eps)
def _scatter_add(tgt, idx, src, axis=0):
    return tgt.clone().index_add_(axis, idx, src)
def _segment_sum(src, seg, n):
    out = torch.zeros((n,) + src.shape[1:], dtype=src.dtype)
    return out.index_add_(0, seg, src)
def _pad(x, pw):
    flat = tuple(v for pair in reversed(pw) for v in pair)
    return torch.nn.functional.pad(x, flat)

kernel_name = 'sequential_preLN__mha_block__dense_activation_gelu__prompt'

def setup_inputs():

    _w = (lambda a: (lambda t: t.to(torch.bfloat16) if t.is_floating_point() else t)(torch.as_tensor(a)))
    def _A_setup():
        B, S, D, H = 1, 2048, 1024, 32
        return {
            "x": _w((lambda *s: torch.randn(*s, dtype=torch.bfloat16) * 0.05)(B, S, D)),
            "wqkv": _w((lambda *s: torch.randn(*s, dtype=torch.bfloat16) * 0.05)(D, 3 * D)),
            "wo": _w((lambda *s: torch.randn(*s, dtype=torch.bfloat16) * 0.05)(D, D)),
        }
    _A_in = _A_setup()

    def _B_setup():
        B, S, D, F = 1, 2048, 1024, 3584
        return {
            "x": _w((lambda *s: torch.randn(*s, dtype=torch.bfloat16) * 0.05)(B, S, D)),
            "w1": _w((lambda *s: torch.randn(*s, dtype=torch.bfloat16) * 3.2)(D, F) * (D ** -0.5)),
            "b1": _w((lambda *s: torch.randn(*s, dtype=torch.bfloat16) * 3.2)(F) * 0.01),
            "w2": _w((lambda *s: torch.randn(*s, dtype=torch.bfloat16) * 0.4)(F, D) * (F ** -0.5)),
            "b2": _w((lambda *s: torch.randn(*s, dtype=torch.bfloat16) * 0.4)(D) * 0.01),
        }
    _B_in = _B_setup()

    return {
        "A_x": _A_in["x"],
        "A_wqkv": _A_in["wqkv"],
        "A_wo": _A_in["wo"],
        "B_x": _B_in["x"],
        "B_w1": _B_in["w1"],
        "B_b1": _B_in["b1"],
        "B_w2": _B_in["w2"],
        "B_b2": _B_in["b2"],
    }

def reference(A_x, A_wqkv, A_wo, B_x, B_w1, B_b1, B_w2, B_b2):
    def _A_ref(x, wqkv, wo):
        B, S, D = x.shape
        H = 32
        Dh = D // H
        qkv = (lambda x, *d: x.permute(*d))((x @ wqkv).reshape(B, S, 3, H, Dh), 2, 0, 3, 1, 4)
        q, k, v = qkv[0], qkv[1], qkv[2]
        scores = torch.einsum("bhqd,bhkd->bhqk", q, k) * (Dh ** -0.5)
        p = _softmax(scores, axis=-1)
        o = torch.einsum("bhqk,bhkd->bhqd", p, v)
        return (lambda x, *d: x.permute(*d))(o, 0, 2, 1, 3).reshape(B, S, D) @ wo

    def _B_ref(x, w1, b1, w2, b2):
        h = torch.einsum("bsd,df->bsf", x, w1) + b1
        h = _gelu(h)
        return torch.einsum("bsf,fd->bsd", h, w2) + b2

    x = A_x
    h = x + _A_ref(_layernorm(x, axis=-1), A_wqkv, A_wo)
    h2 = h + _B_ref(_layernorm(h, axis=-1), B_w1, B_b1, B_w2, B_b2)
    return h2
```

```asm
; @launch kernel=mega_kernel grid=(256,1,1) block=(512,1,1) lds=150528
.amdgcn_target "amdgcn-amd-amdhsa--gfx950"
.text
.globl mega_kernel
.p2align 8
.type mega_kernel,@function
mega_kernel:
s_cmp_ge_u32 s2, 256
s_cbranch_scc1 MEGA_END
s_load_dwordx16 s[64:79], s[0:1], 0
s_load_dwordx4 s[80:83], s[0:1], 64
s_load_dwordx2 s[84:85], s[0:1], 80
v_lshrrev_b32 v1, 6, v0
v_and_b32 v2, 63, v0
v_readfirstlane_b32 s3, v1
s_waitcnt lgkmcnt(0)
s_cmp_lg_u32 s3, 0
s_cbranch_scc1 TK_TOUCH
s_getreg_b32 s52, hwreg(HW_REG_XCC_ID)
s_and_b32 s52, s52, 7
s_mov_b32 s53, 0
v_mov_b32 v4, 1
TK_TRY:
s_lshl_b32 s54, s52, 5
s_add_u32 s54, s54, 16
v_mov_b32 v3, s54
s_mov_b64 exec, 1
global_atomic_add v5, v3, v4, s[82:83] sc0 sc1
s_waitcnt vmcnt(0)
s_mov_b64 exec, -1
v_readfirstlane_b32 s54, v5
s_add_u32 s53, s53, 1
s_cmp_lt_u32 s54, 32
s_cbranch_scc1 TK_GOT
s_add_u32 s52, s52, 1
s_and_b32 s52, s52, 7
s_cmp_lt_u32 s53, 8
s_cbranch_scc1 TK_TRY
s_lshr_b32 s54, s2, 3
s_and_b32 s52, s2, 7
TK_GOT:
s_lshl_b32 s54, s54, 3
s_add_u32 s54, s54, s52
v_mov_b32 v3, 0
v_mov_b32 v4, s54
ds_write_b32 v3, v4
s_waitcnt lgkmcnt(0)
s_branch TK_WAIT
TK_TOUCH:
TK_WAIT:
s_barrier
v_mov_b32 v3, 0
ds_read_b32 v4, v3
s_waitcnt lgkmcnt(0)
v_readfirstlane_b32 s2, v4
s_barrier
s_cmp_ge_u32 s3, 4
s_cbranch_scc1 MEGA_PROD0
s_getpc_b64 s[52:53]
MEGA_PC:
s_sub_u32 s52, s52, MEGA_PC-mega_kernel
s_subb_u32 s53, s53, 0
s_lshr_b32 s54, s2, 3
s_and_b32 s54, s54, 3
s_lshl_b32 s54, s54, 2
s_add_u32 s54, s54, s3
s_mul_i32 s54, s54, ((MEGA_END-mega_kernel)/16)&0xffffff80
v_lshlrev_b32 v1, 7, v2
v_add_u32 v1, s54, v1
v_min_u32 v1, (MEGA_END-mega_kernel)&0xfffffffc, v1
global_load_dword v228, v1, s[52:53]
s_mov_b32 s4, s66
s_mov_b32 s5, s67
s_mov_b32 s6, s84
s_mov_b32 s7, s85
s_mov_b32 s8, s64
s_mov_b32 s9, s65
s_and_b32 s40, s2, 7
s_lshr_b32 s41, s2, 3
s_and_b32 s12, s40, 1
s_lshl_b32 s12, s12, 3
s_and_b32 s42, s41, 7
s_add_u32 s12, s12, s42
s_lshr_b32 s13, s40, 1
s_lshl_b32 s13, s13, 2
s_lshr_b32 s42, s41, 3
s_add_u32 s13, s13, s42
s_waitcnt lgkmcnt(0)
s_lshr_b32 s32, s3, 1
s_and_b32 s33, s3, 1
v_lshrrev_b32 v1, 4, v2
v_bfe_u32 v11, v2, 1, 3
v_xor_b32 v1, v1, v11
v_and_b32 v7, 15, v2
v_lshlrev_b32 v7, 7, v7
v_lshl_add_u32 v7, v1, 4, v7
s_lshl_b32 s34, s32, 13
v_add_u32 v7, s34, v7
v_xor_b32 v8, 64, v7
v_bfe_u32 v1, v2, 2, 2
v_lshlrev_b32 v9, 6, v1
v_and_b32 v1, 3, v2
v_lshl_add_u32 v9, v1, 3, v9
v_lshrrev_b32 v1, 4, v2
v_lshl_add_u32 v9, v1, 10, v9
s_lshl_b32 s34, s33, 8
v_add_u32 v9, s34, v9
v_bfe_u32 v1, v2, 4, 1
v_lshl_add_u32 v9, v1, 5, v9
v_xor_b32 v10, 32, v9
v_mov_b32 v3, v7
v_mov_b32 v4, v8
v_mov_b32 v5, v9
v_mov_b32 v6, v10
v_mov_b32 v92, 0
v_mov_b32 v93, 0
v_mov_b32 v94, 0
v_mov_b32 v95, 0
v_mov_b32 v96, 0
v_mov_b32 v97, 0
v_mov_b32 v98, 0
v_mov_b32 v99, 0
v_mov_b32 v100, 0
v_mov_b32 v101, 0
v_mov_b32 v102, 0
v_mov_b32 v103, 0
v_mov_b32 v104, 0
v_mov_b32 v105, 0
v_mov_b32 v106, 0
v_mov_b32 v107, 0
v_mov_b32 v108, 0
v_mov_b32 v109, 0
v_mov_b32 v110, 0
v_mov_b32 v111, 0
v_mov_b32 v112, 0
v_mov_b32 v113, 0
v_mov_b32 v114, 0
v_mov_b32 v115, 0
v_mov_b32 v116, 0
v_mov_b32 v117, 0
v_mov_b32 v118, 0
v_mov_b32 v119, 0
v_mov_b32 v120, 0
v_mov_b32 v121, 0
v_mov_b32 v122, 0
v_mov_b32 v123, 0
v_mov_b32 v124, 0
v_mov_b32 v125, 0
v_mov_b32 v126, 0
v_mov_b32 v127, 0
v_mov_b32 v128, 0
v_mov_b32 v129, 0
v_mov_b32 v130, 0
v_mov_b32 v131, 0
v_mov_b32 v132, 0
v_mov_b32 v133, 0
v_mov_b32 v134, 0
v_mov_b32 v135, 0
v_mov_b32 v136, 0
v_mov_b32 v137, 0
v_mov_b32 v138, 0
v_mov_b32 v139, 0
v_mov_b32 v140, 0
v_mov_b32 v141, 0
v_mov_b32 v142, 0
v_mov_b32 v143, 0
v_mov_b32 v144, 0
v_mov_b32 v145, 0
v_mov_b32 v146, 0
v_mov_b32 v147, 0
v_mov_b32 v148, 0
v_mov_b32 v149, 0
v_mov_b32 v150, 0
v_mov_b32 v151, 0
v_mov_b32 v152, 0
v_mov_b32 v153, 0
v_mov_b32 v154, 0
v_mov_b32 v155, 0
v_mov_b32 v156, 0
v_mov_b32 v157, 0
v_mov_b32 v158, 0
v_mov_b32 v159, 0
v_mov_b32 v160, 0
v_mov_b32 v161, 0
v_mov_b32 v162, 0
v_mov_b32 v163, 0
v_mov_b32 v164, 0
v_mov_b32 v165, 0
v_mov_b32 v166, 0
v_mov_b32 v167, 0
v_mov_b32 v168, 0
v_mov_b32 v169, 0
v_mov_b32 v170, 0
v_mov_b32 v171, 0
v_mov_b32 v172, 0
v_mov_b32 v173, 0
v_mov_b32 v174, 0
v_mov_b32 v175, 0
v_mov_b32 v176, 0
v_mov_b32 v177, 0
v_mov_b32 v178, 0
v_mov_b32 v179, 0
v_mov_b32 v180, 0
v_mov_b32 v181, 0
v_mov_b32 v182, 0
v_mov_b32 v183, 0
v_mov_b32 v184, 0
v_mov_b32 v185, 0
v_mov_b32 v186, 0
v_mov_b32 v187, 0
s_mov_b32 s28, s8
s_mov_b32 s29, s9
s_mov_b32 s30, 4194304
s_mov_b32 s31, 0x20000
v_lshrrev_b32 v1, 5, v2
v_lshlrev_b32 v1, 11, v1
v_and_b32 v11, 31, v2
v_lshl_add_u32 v1, v11, 4, v1
s_lshl_b32 s36, s12, 4
s_add_u32 s36, s36, s13
s_lshl_b32 s36, s36, 2
s_add_u32 s36, s36, s3
s_lshl_b32 s45, s36, 1
s_lshl_b32 s36, s36, 12
buffer_load_dwordx4 v[188:191], v1, s[28:31], s36 offen offset:0
buffer_load_dwordx4 v[192:195], v1, s[28:31], s36 offen offset:512
buffer_load_dwordx4 v[196:199], v1, s[28:31], s36 offen offset:1024
buffer_load_dwordx4 v[200:203], v1, s[28:31], s36 offen offset:1536
s_mov_b32 s14, 0
s_barrier
v_mov_b32 v12, 0x3f803f80
v_mov_b32 v13, 0x3f803f80
v_mov_b32 v14, 0x3f803f80
v_mov_b32 v15, 0x3f803f80
s_mov_b32 s24, s6
s_mov_b32 s25, s7
s_mov_b32 s26, 48234496
s_mov_b32 s27, 0x20000
s_lshl_b32 s37, s32, 13
s_add_u32 s37, s37, 81920
v_add_u32 v1, s37, v9
v_add_u32 v11, s37, v10
ds_read_b64_tr_b16 v[44:45], v1 offset:16384
ds_read_b64_tr_b16 v[46:47], v1 offset:16896
ds_read_b64_tr_b16 v[48:49], v1 offset:20480
ds_read_b64_tr_b16 v[50:51], v1 offset:20992
ds_read_b64_tr_b16 v[52:53], v11 offset:16384
ds_read_b64_tr_b16 v[54:55], v11 offset:16896
ds_read_b64_tr_b16 v[56:57], v11 offset:20480
ds_read_b64_tr_b16 v[58:59], v11 offset:20992
ds_read_b64_tr_b16 v[60:61], v1 offset:24576
ds_read_b64_tr_b16 v[62:63], v1 offset:25088
ds_read_b64_tr_b16 v[64:65], v1 offset:28672
ds_read_b64_tr_b16 v[66:67], v1 offset:29184
ds_read_b64_tr_b16 v[68:69], v11 offset:24576
ds_read_b64_tr_b16 v[70:71], v11 offset:25088
ds_read_b64_tr_b16 v[72:73], v11 offset:28672
ds_read_b64_tr_b16 v[74:75], v11 offset:29184
s_waitcnt vmcnt(0)
s_mov_b32 s39, 0xffff0000
v_mov_b32 v220, 0
v_mov_b32 v221, 0
v_mov_b32 v222, 0
v_mov_b32 v223, 0
v_lshlrev_b32 v224, 16, v188
v_and_b32 v225, s39, v188
v_pk_add_f32 v[220:221], v[224:225], v[220:221]
v_pk_fma_f32 v[222:223], v[224:225], v[224:225], v[222:223]
v_lshlrev_b32 v226, 16, v189
v_and_b32 v227, s39, v189
v_pk_add_f32 v[220:221], v[226:227], v[220:221]
v_pk_fma_f32 v[222:223], v[226:227], v[226:227], v[222:223]
v_lshlrev_b32 v224, 16, v190
v_and_b32 v225, s39, v190
v_pk_add_f32 v[220:221], v[224:225], v[220:221]
v_pk_fma_f32 v[222:223], v[224:225], v[224:225], v[222:223]
v_lshlrev_b32 v226, 16, v191
v_and_b32 v227, s39, v191
v_pk_add_f32 v[220:221], v[226:227], v[220:221]
v_pk_fma_f32 v[222:223], v[226:227], v[226:227], v[222:223]
v_lshlrev_b32 v224, 16, v192
v_and_b32 v225, s39, v192
v_pk_add_f32 v[220:221], v[224:225], v[220:221]
v_pk_fma_f32 v[222:223], v[224:225], v[224:225], v[222:223]
v_lshlrev_b32 v226, 16, v193
v_and_b32 v227, s39, v193
v_pk_add_f32 v[220:221], v[226:227], v[220:221]
v_pk_fma_f32 v[222:223], v[226:227], v[226:227], v[222:223]
v_lshlrev_b32 v224, 16, v194
v_and_b32 v225, s39, v194
v_pk_add_f32 v[220:221], v[224:225], v[220:221]
v_pk_fma_f32 v[222:223], v[224:225], v[224:225], v[222:223]
v_lshlrev_b32 v226, 16, v195
v_and_b32 v227, s39, v195
v_pk_add_f32 v[220:221], v[226:227], v[220:221]
v_pk_fma_f32 v[222:223], v[226:227], v[226:227], v[222:223]
v_lshlrev_b32 v224, 16, v196
v_and_b32 v225, s39, v196
v_pk_add_f32 v[220:221], v[224:225], v[220:221]
v_pk_fma_f32 v[222:223], v[224:225], v[224:225], v[222:223]
v_lshlrev_b32 v226, 16, v197
v_and_b32 v227, s39, v197
v_pk_add_f32 v[220:221], v[226:227], v[220:221]
v_pk_fma_f32 v[222:223], v[226:227], v[226:227], v[222:223]
v_lshlrev_b32 v224, 16, v198
v_and_b32 v225, s39, v198
v_pk_add_f32 v[220:221], v[224:225], v[220:221]
v_pk_fma_f32 v[222:223], v[224:225], v[224:225], v[222:223]
v_lshlrev_b32 v226, 16, v199
v_and_b32 v227, s39, v199
v_pk_add_f32 v[220:221], v[226:227], v[220:221]
v_pk_fma_f32 v[222:223], v[226:227], v[226:227], v[222:223]
v_lshlrev_b32 v224, 16, v200
v_and_b32 v225, s39, v200
v_pk_add_f32 v[220:221], v[224:225], v[220:221]
v_pk_fma_f32 v[222:223], v[224:225], v[224:225], v[222:223]
v_lshlrev_b32 v226, 16, v201
v_and_b32 v227, s39, v201
v_pk_add_f32 v[220:221], v[226:227], v[220:221]
v_pk_fma_f32 v[222:223], v[226:227], v[226:227], v[222:223]
v_lshlrev_b32 v224, 16, v202
v_and_b32 v225, s39, v202
v_pk_add_f32 v[220:221], v[224:225], v[220:221]
v_pk_fma_f32 v[222:223], v[224:225], v[224:225], v[222:223]
v_lshlrev_b32 v226, 16, v203
v_and_b32 v227, s39, v203
v_pk_add_f32 v[220:221], v[226:227], v[220:221]
v_pk_fma_f32 v[222:223], v[226:227], v[226:227], v[222:223]
s_waitcnt lgkmcnt(0)
v_mfma_f32_16x16x32_bf16 v[204:207], v[44:47], v[12:15], 0
v_mfma_f32_16x16x32_bf16 v[208:211], v[52:55], v[12:15], 0
v_mfma_f32_16x16x32_bf16 v[212:215], v[60:63], v[12:15], 0
v_mfma_f32_16x16x32_bf16 v[216:219], v[68:71], v[12:15], 0
v_mfma_f32_16x16x32_bf16 v[204:207], v[48:51], v[12:15], v[204:207]
v_mfma_f32_16x16x32_bf16 v[208:211], v[56:59], v[12:15], v[208:211]
v_mfma_f32_16x16x32_bf16 v[212:215], v[64:67], v[12:15], v[212:215]
v_mfma_f32_16x16x32_bf16 v[216:219], v[72:75], v[12:15], v[216:219]
v_add_f32 v220, v220, v221
v_add_f32 v221, v222, v223
s_nop 1
v_add_f32_dpp v220, v220, v220 quad_perm:[1,0,3,2] row_mask:0xf bank_mask:0xf
v_add_f32_dpp v221, v221, v221 quad_perm:[1,0,3,2] row_mask:0xf bank_mask:0xf
s_nop 1
v_add_f32_dpp v220, v220, v220 quad_perm:[2,3,0,1] row_mask:0xf bank_mask:0xf
v_add_f32_dpp v221, v221, v221 quad_perm:[2,3,0,1] row_mask:0xf bank_mask:0xf
s_nop 1
v_add_f32_dpp v220, v220, v220 row_half_mirror row_mask:0xf bank_mask:0xf
v_add_f32_dpp v221, v221, v221 row_half_mirror row_mask:0xf bank_mask:0xf
s_nop 1
v_add_f32_dpp v220, v220, v220 row_mirror row_mask:0xf bank_mask:0xf
v_add_f32_dpp v221, v221, v221 row_mirror row_mask:0xf bank_mask:0xf
v_mov_b32 v222, v220
v_mov_b32 v223, v221
s_nop 1
v_permlane16_swap_b32 v220, v222
v_permlane16_swap_b32 v221, v223
s_nop 0
v_add_f32 v220, v220, v222
v_add_f32 v221, v221, v223
v_mul_f32 v220, 0x3a800000, v220
v_mul_f32 v221, 0x3a800000, v221
v_fma_f32 v221, -v220, v220, v221
v_add_f32 v221, 0x3727c5ac, v221
v_rsq_f32 v222, v221
s_nop 0
v_mul_f32 v223, v220, v222
v_sub_f32 v223, 0, v223
s_mul_i32 s36, s13, 12288
s_mul_i32 s37, s12, 768
s_add_u32 s36, s36, s37
s_add_u32 s36, s36, 45088768
s_lshl_b32 s37, s32, 8
s_add_u32 s36, s36, s37
s_lshl_b32 s37, s33, 7
s_add_u32 s36, s36, s37
v_lshrrev_b32 v1, 4, v2
v_lshlrev_b32 v1, 4, v1
s_mov_b32 exec_lo, 0x00010001
s_mov_b32 exec_hi, 0x00010001
buffer_store_dwordx4 v[204:207], v1, s[24:27], s36 offen offset:0 sc1
buffer_store_dwordx4 v[208:211], v1, s[24:27], s36 offen offset:64 sc1
buffer_store_dwordx4 v[212:215], v1, s[24:27], s36 offen offset:256 sc1
buffer_store_dwordx4 v[216:219], v1, s[24:27], s36 offen offset:320 sc1
s_mov_b64 exec, -1
v_lshrrev_b32 v11, 5, v2
v_lshlrev_b32 v11, 3, v11
s_lshl_b32 s36, s45, 3
s_add_u32 s36, s36, 44040192
s_mov_b32 exec_lo, 1
s_mov_b32 exec_hi, 1
buffer_store_dwordx2 v[222:223], v11, s[24:27], s36 offen sc1
s_mov_b64 exec, -1
s_barrier
s_setprio 1
ds_read_b128 v[12:15], v3 offset:0
ds_read_b64_tr_b16 v[44:45], v5 offset:16384
ds_read_b64_tr_b16 v[46:47], v5 offset:16896
ds_read_b128 v[16:19], v3 offset:2048
ds_read_b128 v[20:23], v3 offset:4096
ds_read_b128 v[24:27], v3 offset:6144
ds_read_b64_tr_b16 v[48:49], v6 offset:16384
ds_read_b64_tr_b16 v[50:51], v6 offset:16896
ds_read_b64_tr_b16 v[52:53], v5 offset:24576
ds_read_b64_tr_b16 v[54:55], v5 offset:25088
ds_read_b64_tr_b16 v[56:57], v6 offset:24576
ds_read_b64_tr_b16 v[58:59], v6 offset:25088
ds_read_b64_tr_b16 v[60:61], v5 offset:32768
ds_read_b64_tr_b16 v[62:63], v5 offset:33280
ds_read_b64_tr_b16 v[64:65], v6 offset:32768
ds_read_b64_tr_b16 v[66:67], v6 offset:33280
s_mov_b32 s15, 16
.p2align 4
QKV_CLOOP:
s_waitcnt lgkmcnt(10)
v_mfma_f32_16x16x32_bf16 v[92:95], v[44:47], v[12:15], v[92:95]
s_cmp_eq_u32 s15, 14
s_cbranch_scc1 QKV_DOVM
QKV_NOVM:
ds_read_b128 v[28:31], v4 offset:0
v_mfma_f32_16x16x32_bf16 v[96:99], v[44:47], v[16:19], v[96:99]
ds_read_b64_tr_b16 v[68:69], v5 offset:20480
v_mfma_f32_16x16x32_bf16 v[100:103], v[44:47], v[20:23], v[100:103]
ds_read_b64_tr_b16 v[70:71], v5 offset:20992
v_mfma_f32_16x16x32_bf16 v[104:107], v[44:47], v[24:27], v[104:107]
ds_read_b128 v[32:35], v4 offset:2048
s_waitcnt lgkmcnt(12)
v_mfma_f32_16x16x32_bf16 v[108:111], v[48:51], v[12:15], v[108:111]
ds_read_b128 v[36:39], v4 offset:4096
v_mfma_f32_16x16x32_bf16 v[112:115], v[48:51], v[16:19], v[112:115]
ds_read_b128 v[40:43], v4 offset:6144
v_mfma_f32_16x16x32_bf16 v[116:119], v[48:51], v[20:23], v[116:119]
ds_read_b64_tr_b16 v[72:73], v6 offset:20480
v_mfma_f32_16x16x32_bf16 v[120:123], v[48:51], v[24:27], v[120:123]
ds_read_b64_tr_b16 v[74:75], v6 offset:20992
s_waitcnt lgkmcnt(14)
v_mfma_f32_16x16x32_bf16 v[124:127], v[52:55], v[12:15], v[124:127]
v_mfma_f32_16x16x32_bf16 v[128:131], v[52:55], v[16:19], v[128:131]
ds_read_b64_tr_b16 v[76:77], v5 offset:28672
v_mfma_f32_16x16x32_bf16 v[132:135], v[52:55], v[20:23], v[132:135]
ds_read_b64_tr_b16 v[78:79], v5 offset:29184
v_mfma_f32_16x16x32_bf16 v[136:139], v[52:55], v[24:27], v[136:139]
ds_read_b64_tr_b16 v[80:81], v6 offset:28672
s_waitcnt lgkmcnt(15)
v_mfma_f32_16x16x32_bf16 v[140:143], v[56:59], v[12:15], v[140:143]
ds_read_b64_tr_b16 v[82:83], v6 offset:29184
v_mfma_f32_16x16x32_bf16 v[144:147], v[56:59], v[16:19], v[144:147]
ds_read_b64_tr_b16 v[84:85], v5 offset:36864
v_mfma_f32_16x16x32_bf16 v[148:151], v[56:59], v[20:23], v[148:151]
ds_read_b64_tr_b16 v[86:87], v5 offset:37376
v_mfma_f32_16x16x32_bf16 v[152:155], v[56:59], v[24:27], v[152:155]
ds_read_b64_tr_b16 v[88:89], v6 offset:36864
s_waitcnt lgkmcnt(15)
v_mfma_f32_16x16x32_bf16 v[156:159], v[12:15], v[60:63], v[156:159]
ds_read_b64_tr_b16 v[90:91], v6 offset:37376
s_add_u32 s14, s14, 40960
v_mfma_f32_16x16x32_bf16 v[160:163], v[16:19], v[60:63], v[160:163]
s_cmp_eq_u32 s14, 122880
v_mfma_f32_16x16x32_bf16 v[164:167], v[20:23], v[60:63], v[164:167]
s_cselect_b32 s14, 0, s14
v_mfma_f32_16x16x32_bf16 v[168:171], v[24:27], v[60:63], v[168:171]
v_add_u32 v3, s14, v7
s_waitcnt lgkmcnt(15)
v_mfma_f32_16x16x32_bf16 v[172:175], v[12:15], v[64:67], v[172:175]
v_add_u32 v4, s14, v8
v_mfma_f32_16x16x32_bf16 v[176:179], v[16:19], v[64:67], v[176:179]
v_add_u32 v5, s14, v9
v_mfma_f32_16x16x32_bf16 v[180:183], v[20:23], v[64:67], v[180:183]
v_add_u32 v6, s14, v10
v_mfma_f32_16x16x32_bf16 v[184:187], v[24:27], v[64:67], v[184:187]
s_waitcnt lgkmcnt(10)
v_mfma_f32_16x16x32_bf16 v[92:95], v[68:71], v[28:31], v[92:95]
v_mfma_f32_16x16x32_bf16 v[96:99], v[68:71], v[32:35], v[96:99]
v_mfma_f32_16x16x32_bf16 v[100:103], v[68:71], v[36:39], v[100:103]
v_mfma_f32_16x16x32_bf16 v[104:107], v[68:71], v[40:43], v[104:107]
s_waitcnt lgkmcnt(0)
s_barrier
ds_read_b128 v[12:15], v3 offset:0
v_mfma_f32_16x16x32_bf16 v[108:111], v[72:75], v[28:31], v[108:111]
ds_read_b64_tr_b16 v[44:45], v5 offset:16384
v_mfma_f32_16x16x32_bf16 v[112:115], v[72:75], v[32:35], v[112:115]
ds_read_b64_tr_b16 v[46:47], v5 offset:16896
v_mfma_f32_16x16x32_bf16 v[116:119], v[72:75], v[36:39], v[116:119]
ds_read_b128 v[16:19], v3 offset:2048
v_mfma_f32_16x16x32_bf16 v[120:123], v[72:75], v[40:43], v[120:123]
ds_read_b128 v[20:23], v3 offset:4096
v_mfma_f32_16x16x32_bf16 v[124:127], v[76:79], v[28:31], v[124:127]
ds_read_b128 v[24:27], v3 offset:6144
v_mfma_f32_16x16x32_bf16 v[128:131], v[76:79], v[32:35], v[128:131]
ds_read_b64_tr_b16 v[48:49], v6 offset:16384
v_mfma_f32_16x16x32_bf16 v[132:135], v[76:79], v[36:39], v[132:135]
ds_read_b64_tr_b16 v[50:51], v6 offset:16896
v_mfma_f32_16x16x32_bf16 v[136:139], v[76:79], v[40:43], v[136:139]
v_mfma_f32_16x16x32_bf16 v[140:143], v[80:83], v[28:31], v[140:143]
ds_read_b64_tr_b16 v[52:53], v5 offset:24576
v_mfma_f32_16x16x32_bf16 v[144:147], v[80:83], v[32:35], v[144:147]
ds_read_b64_tr_b16 v[54:55], v5 offset:25088
v_mfma_f32_16x16x32_bf16 v[148:151], v[80:83], v[36:39], v[148:151]
ds_read_b64_tr_b16 v[56:57], v6 offset:24576
v_mfma_f32_16x16x32_bf16 v[152:155], v[80:83], v[40:43], v[152:155]
ds_read_b64_tr_b16 v[58:59], v6 offset:25088
v_mfma_f32_16x16x32_bf16 v[156:159], v[28:31], v[84:87], v[156:159]
ds_read_b64_tr_b16 v[60:61], v5 offset:32768
v_mfma_f32_16x16x32_bf16 v[160:163], v[32:35], v[84:87], v[160:163]
ds_read_b64_tr_b16 v[62:63], v5 offset:33280
v_mfma_f32_16x16x32_bf16 v[164:167], v[36:39], v[84:87], v[164:167]
ds_read_b64_tr_b16 v[64:65], v6 offset:32768
v_mfma_f32_16x16x32_bf16 v[168:171], v[40:43], v[84:87], v[168:171]
ds_read_b64_tr_b16 v[66:67], v6 offset:33280
v_mfma_f32_16x16x32_bf16 v[172:175], v[28:31], v[88:91], v[172:175]
v_mfma_f32_16x16x32_bf16 v[176:179], v[32:35], v[88:91], v[176:179]
v_mfma_f32_16x16x32_bf16 v[180:183], v[36:39], v[88:91], v[180:183]
s_sub_u32 s15, s15, 1
s_cmp_lg_u32 s15, 0
v_mfma_f32_16x16x32_bf16 v[184:187], v[40:43], v[88:91], v[184:187]
s_cbranch_scc1 QKV_CLOOP
s_waitcnt lgkmcnt(0)
s_setprio 0
s_barrier
s_nop 7
s_mov_b32 s16, s6
s_mov_b32 s17, s7
s_mov_b32 s18, 12582912
s_mov_b32 s19, 0x20000
v_bfe_u32 v9, v2, 5, 1
v_bfe_u32 v10, v2, 4, 1
v_and_b32 v11, 15, v2
v_lshlrev_b32 v3, 4, v11
v_lshl_add_u32 v3, v10, 9, v3
v_lshl_add_u32 v3, v9, 8, v3
v_lshrrev_b32 v1, 4, v2
v_lshlrev_b32 v1, 4, v1
v_lshlrev_b32 v11, 2, v11
s_lshl_b32 s40, s33, 7
s_add_u32 s40, s40, 122880
s_lshl_b32 s41, s32, 8
s_add_u32 s41, s41, 122880
v_add_u32 v4, s40, v1
v_add_u32 v5, s40, v11
v_add_u32 v6, s41, v1
v_add_u32 v7, s41, v11
s_lshl_b32 s36, s13, 1
s_add_u32 s36, s36, s33
s_lshl_b32 s36, s36, 6
s_lshl_b32 s37, s12, 2
s_lshl_b32 s38, s32, 1
s_add_u32 s37, s37, s38
s_add_u32 s36, s36, s37
s_lshl_b32 s36, s36, 11
s_mov_b32 s39, 0x3e8293ee
ds_read_b32 v12, v7 offset:1024
ds_read_b32 v20, v7 offset:1536
ds_read_b32 v14, v7 offset:1088
ds_read_b32 v22, v7 offset:1600
ds_read_b32 v16, v7 offset:1152
ds_read_b32 v24, v7 offset:1664
ds_read_b32 v18, v7 offset:1216
ds_read_b32 v26, v7 offset:1728
ds_read_b128 v[44:47], v4 offset:0
ds_read_b128 v[48:51], v4 offset:64
ds_read_b128 v[52:55], v4 offset:256
ds_read_b128 v[56:59], v4 offset:320
ds_read_b32 v188, v5 offset:512
ds_read_b32 v190, v5 offset:576
s_waitcnt lgkmcnt(6)
v_mov_b32 v13, v12
v_mov_b32 v21, v20
v_mul_f32 v28, s39, v12
v_mul_f32 v29, s39, v12
v_mul_f32 v36, s39, v20
v_mul_f32 v37, s39, v20
v_mov_b32 v15, v14
v_mov_b32 v23, v22
v_mul_f32 v30, s39, v14
v_mul_f32 v31, s39, v14
v_mul_f32 v38, s39, v22
v_mul_f32 v39, s39, v22
v_mov_b32 v17, v16
v_mov_b32 v25, v24
v_mul_f32 v32, s39, v16
v_mul_f32 v33, s39, v16
v_mul_f32 v40, s39, v24
v_mul_f32 v41, s39, v24
v_mov_b32 v19, v18
v_mov_b32 v27, v26
v_mul_f32 v34, s39, v18
v_mul_f32 v35, s39, v18
v_mul_f32 v42, s39, v26
v_mul_f32 v43, s39, v26
ds_read_b128 v[192:195], v6 offset:1024
ds_read_b128 v[208:211], v6 offset:1536
ds_read_b128 v[196:199], v6 offset:1088
ds_read_b128 v[212:215], v6 offset:1600
ds_read_b128 v[200:203], v6 offset:1152
ds_read_b128 v[216:219], v6 offset:1664
ds_read_b128 v[204:207], v6 offset:1216
ds_read_b128 v[220:223], v6 offset:1728
s_waitcnt lgkmcnt(8)
v_pk_mul_f32 v[60:61], v[44:45], v[36:37]
v_pk_mul_f32 v[62:63], v[46:47], v[36:37]
v_pk_mul_f32 v[64:65], v[44:45], v[38:39]
v_pk_mul_f32 v[66:67], v[46:47], v[38:39]
v_pk_mul_f32 v[68:69], v[44:45], v[40:41]
v_pk_mul_f32 v[70:71], v[46:47], v[40:41]
v_pk_mul_f32 v[72:73], v[44:45], v[42:43]
v_pk_mul_f32 v[74:75], v[46:47], v[42:43]
v_pk_fma_f32 v[92:93], v[92:93], v[28:29], v[60:61]
v_pk_fma_f32 v[94:95], v[94:95], v[28:29], v[62:63]
v_pk_fma_f32 v[96:97], v[96:97], v[30:31], v[64:65]
v_pk_fma_f32 v[98:99], v[98:99], v[30:31], v[66:67]
v_pk_fma_f32 v[100:101], v[100:101], v[32:33], v[68:69]
v_pk_fma_f32 v[102:103], v[102:103], v[32:33], v[70:71]
v_pk_fma_f32 v[104:105], v[104:105], v[34:35], v[72:73]
v_pk_fma_f32 v[106:107], v[106:107], v[34:35], v[74:75]
v_cvt_pk_bf16_f32 v76, v92, v93
v_cvt_pk_bf16_f32 v77, v94, v95
v_cvt_pk_bf16_f32 v78, v96, v97
v_cvt_pk_bf16_f32 v79, v98, v99
s_add_u32 s40, s36, 0
s_nop 0
v_permlane32_swap_b32 v76, v78
v_permlane32_swap_b32 v77, v79
buffer_store_dwordx4 v[76:79], v3, s[16:19], s40 offen sc1
v_cvt_pk_bf16_f32 v80, v100, v101
v_cvt_pk_bf16_f32 v81, v102, v103
v_cvt_pk_bf16_f32 v82, v104, v105
v_cvt_pk_bf16_f32 v83, v106, v107
s_add_u32 s40, s36, 2048
s_nop 0
v_permlane32_swap_b32 v80, v82
v_permlane32_swap_b32 v81, v83
buffer_store_dwordx4 v[80:83], v3, s[16:19], s40 offen sc1
v_pk_mul_f32 v[60:61], v[48:49], v[36:37]
v_pk_mul_f32 v[62:63], v[50:51], v[36:37]
v_pk_mul_f32 v[64:65], v[48:49], v[38:39]
v_pk_mul_f32 v[66:67], v[50:51], v[38:39]
v_pk_mul_f32 v[68:69], v[48:49], v[40:41]
v_pk_mul_f32 v[70:71], v[50:51], v[40:41]
v_pk_mul_f32 v[72:73], v[48:49], v[42:43]
v_pk_mul_f32 v[74:75], v[50:51], v[42:43]
v_pk_fma_f32 v[108:109], v[108:109], v[28:29], v[60:61]
v_pk_fma_f32 v[110:111], v[110:111], v[28:29], v[62:63]
v_pk_fma_f32 v[112:113], v[112:113], v[30:31], v[64:65]
v_pk_fma_f32 v[114:115], v[114:115], v[30:31], v[66:67]
v_pk_fma_f32 v[116:117], v[116:117], v[32:33], v[68:69]
v_pk_fma_f32 v[118:119], v[118:119], v[32:33], v[70:71]
v_pk_fma_f32 v[120:121], v[120:121], v[34:35], v[72:73]
v_pk_fma_f32 v[122:123], v[122:123], v[34:35], v[74:75]
v_cvt_pk_bf16_f32 v84, v108, v109
v_cvt_pk_bf16_f32 v85, v110, v111
v_cvt_pk_bf16_f32 v86, v112, v113
v_cvt_pk_bf16_f32 v87, v114, v115
s_add_u32 s40, s36, 1024
s_nop 0
v_permlane32_swap_b32 v84, v86
v_permlane32_swap_b32 v85, v87
buffer_store_dwordx4 v[84:87], v3, s[16:19], s40 offen sc1
v_cvt_pk_bf16_f32 v88, v116, v117
v_cvt_pk_bf16_f32 v89, v118, v119
v_cvt_pk_bf16_f32 v90, v120, v121
v_cvt_pk_bf16_f32 v91, v122, v123
s_add_u32 s40, s36, 3072
s_nop 0
v_permlane32_swap_b32 v88, v90
v_permlane32_swap_b32 v89, v91
buffer_store_dwordx4 v[88:91], v3, s[16:19], s40 offen sc1
v_pk_mul_f32 v[60:61], v[52:53], v[20:21]
v_pk_mul_f32 v[62:63], v[54:55], v[20:21]
v_pk_mul_f32 v[64:65], v[52:53], v[22:23]
v_pk_mul_f32 v[66:67], v[54:55], v[22:23]
v_pk_mul_f32 v[68:69], v[52:53], v[24:25]
v_pk_mul_f32 v[70:71], v[54:55], v[24:25]
v_pk_mul_f32 v[72:73], v[52:53], v[26:27]
v_pk_mul_f32 v[74:75], v[54:55], v[26:27]
v_pk_fma_f32 v[124:125], v[124:125], v[12:13], v[60:61]
v_pk_fma_f32 v[126:127], v[126:127], v[12:13], v[62:63]
v_pk_fma_f32 v[128:129], v[128:129], v[14:15], v[64:65]
v_pk_fma_f32 v[130:131], v[130:131], v[14:15], v[66:67]
v_pk_fma_f32 v[132:133], v[132:133], v[16:17], v[68:69]
v_pk_fma_f32 v[134:135], v[134:135], v[16:17], v[70:71]
v_pk_fma_f32 v[136:137], v[136:137], v[18:19], v[72:73]
v_pk_fma_f32 v[138:139], v[138:139], v[18:19], v[74:75]
v_cvt_pk_bf16_f32 v76, v124, v125
v_cvt_pk_bf16_f32 v77, v126, v127
v_cvt_pk_bf16_f32 v78, v128, v129
v_cvt_pk_bf16_f32 v79, v130, v131
s_add_u32 s40, s36, 4194304
s_nop 0
v_permlane32_swap_b32 v76, v78
v_permlane32_swap_b32 v77, v79
buffer_store_dwordx4 v[76:79], v3, s[16:19], s40 offen sc1
v_cvt_pk_bf16_f32 v80, v132, v133
v_cvt_pk_bf16_f32 v81, v134, v135
v_cvt_pk_bf16_f32 v82, v136, v137
v_cvt_pk_bf16_f32 v83, v138, v139
s_add_u32 s40, s36, 4196352
s_nop 0
v_permlane32_swap_b32 v80, v82
v_permlane32_swap_b32 v81, v83
buffer_store_dwordx4 v[80:83], v3, s[16:19], s40 offen sc1
v_pk_mul_f32 v[60:61], v[56:57], v[20:21]
v_pk_mul_f32 v[62:63], v[58:59], v[20:21]
v_pk_mul_f32 v[64:65], v[56:57], v[22:23]
v_pk_mul_f32 v[66:67], v[58:59], v[22:23]
v_pk_mul_f32 v[68:69], v[56:57], v[24:25]
v_pk_mul_f32 v[70:71], v[58:59], v[24:25]
v_pk_mul_f32 v[72:73], v[56:57], v[26:27]
v_pk_mul_f32 v[74:75], v[58:59], v[26:27]
v_pk_fma_f32 v[140:141], v[140:141], v[12:13], v[60:61]
v_pk_fma_f32 v[142:143], v[142:143], v[12:13], v[62:63]
v_pk_fma_f32 v[144:145], v[144:145], v[14:15], v[64:65]
v_pk_fma_f32 v[146:147], v[146:147], v[14:15], v[66:67]
v_pk_fma_f32 v[148:149], v[148:149], v[16:17], v[68:69]
v_pk_fma_f32 v[150:151], v[150:151], v[16:17], v[70:71]
v_pk_fma_f32 v[152:153], v[152:153], v[18:19], v[72:73]
v_pk_fma_f32 v[154:155], v[154:155], v[18:19], v[74:75]
v_cvt_pk_bf16_f32 v84, v140, v141
v_cvt_pk_bf16_f32 v85, v142, v143
v_cvt_pk_bf16_f32 v86, v144, v145
v_cvt_pk_bf16_f32 v87, v146, v147
s_add_u32 s40, s36, 4195328
s_nop 0
v_permlane32_swap_b32 v84, v86
v_permlane32_swap_b32 v85, v87
buffer_store_dwordx4 v[84:87], v3, s[16:19], s40 offen sc1
v_cvt_pk_bf16_f32 v88, v148, v149
v_cvt_pk_bf16_f32 v89, v150, v151
v_cvt_pk_bf16_f32 v90, v152, v153
v_cvt_pk_bf16_f32 v91, v154, v155
s_add_u32 s40, s36, 4197376
s_nop 0
v_permlane32_swap_b32 v88, v90
v_permlane32_swap_b32 v89, v91
buffer_store_dwordx4 v[88:91], v3, s[16:19], s40 offen sc1
s_waitcnt lgkmcnt(0)
v_mov_b32 v189, v188
v_mov_b32 v191, v190
v_pk_mul_f32 v[60:61], v[208:209], v[188:189]
v_pk_mul_f32 v[62:63], v[210:211], v[188:189]
v_pk_fma_f32 v[156:157], v[156:157], v[192:193], v[60:61]
v_pk_fma_f32 v[158:159], v[158:159], v[194:195], v[62:63]
v_pk_mul_f32 v[60:61], v[208:209], v[190:191]
v_pk_mul_f32 v[62:63], v[210:211], v[190:191]
v_pk_fma_f32 v[172:173], v[172:173], v[192:193], v[60:61]
v_pk_fma_f32 v[174:175], v[174:175], v[194:195], v[62:63]
v_cvt_pk_bf16_f32 v76, v156, v157
v_cvt_pk_bf16_f32 v77, v158, v159
v_cvt_pk_bf16_f32 v78, v172, v173
v_cvt_pk_bf16_f32 v79, v174, v175
s_add_u32 s40, s36, 8388608
s_nop 0
v_permlane32_swap_b32 v76, v78
v_permlane32_swap_b32 v77, v79
buffer_store_dwordx4 v[76:79], v3, s[16:19], s40 offen sc1
v_pk_mul_f32 v[60:61], v[212:213], v[188:189]
v_pk_mul_f32 v[62:63], v[214:215], v[188:189]
v_pk_fma_f32 v[160:161], v[160:161], v[196:197], v[60:61]
v_pk_fma_f32 v[162:163], v[162:163], v[198:199], v[62:63]
v_pk_mul_f32 v[60:61], v[212:213], v[190:191]
v_pk_mul_f32 v[62:63], v[214:215], v[190:191]
v_pk_fma_f32 v[176:177], v[176:177], v[196:197], v[60:61]
v_pk_fma_f32 v[178:179], v[178:179], v[198:199], v[62:63]
v_cvt_pk_bf16_f32 v80, v160, v161
v_cvt_pk_bf16_f32 v81, v162, v163
v_cvt_pk_bf16_f32 v82, v176, v177
v_cvt_pk_bf16_f32 v83, v178, v179
s_add_u32 s40, s36, 8389632
s_nop 0
v_permlane32_swap_b32 v80, v82
v_permlane32_swap_b32 v81, v83
buffer_store_dwordx4 v[80:83], v3, s[16:19], s40 offen sc1
v_pk_mul_f32 v[60:61], v[216:217], v[188:189]
v_pk_mul_f32 v[62:63], v[218:219], v[188:189]
v_pk_fma_f32 v[164:165], v[164:165], v[200:201], v[60:61]
v_pk_fma_f32 v[166:167], v[166:167], v[202:203], v[62:63]
v_pk_mul_f32 v[60:61], v[216:217], v[190:191]
v_pk_mul_f32 v[62:63], v[218:219], v[190:191]
v_pk_fma_f32 v[180:181], v[180:181], v[200:201], v[60:61]
v_pk_fma_f32 v[182:183], v[182:183], v[202:203], v[62:63]
v_cvt_pk_bf16_f32 v84, v164, v165
v_cvt_pk_bf16_f32 v85, v166, v167
v_cvt_pk_bf16_f32 v86, v180, v181
v_cvt_pk_bf16_f32 v87, v182, v183
s_add_u32 s40, s36, 8390656
s_nop 0
v_permlane32_swap_b32 v84, v86
v_permlane32_swap_b32 v85, v87
buffer_store_dwordx4 v[84:87], v3, s[16:19], s40 offen sc1
v_pk_mul_f32 v[60:61], v[220:221], v[188:189]
v_pk_mul_f32 v[62:63], v[222:223], v[188:189]
v_pk_fma_f32 v[168:169], v[168:169], v[204:205], v[60:61]
v_pk_fma_f32 v[170:171], v[170:171], v[206:207], v[62:63]
v_pk_mul_f32 v[60:61], v[220:221], v[190:191]
v_pk_mul_f32 v[62:63], v[222:223], v[190:191]
v_pk_fma_f32 v[184:185], v[184:185], v[204:205], v[60:61]
v_pk_fma_f32 v[186:187], v[186:187], v[206:207], v[62:63]
v_cvt_pk_bf16_f32 v88, v168, v169
v_cvt_pk_bf16_f32 v89, v170, v171
v_cvt_pk_bf16_f32 v90, v184, v185
v_cvt_pk_bf16_f32 v91, v186, v187
s_add_u32 s40, s36, 8391680
s_nop 0
v_permlane32_swap_b32 v88, v90
v_permlane32_swap_b32 v89, v91
buffer_store_dwordx4 v[88:91], v3, s[16:19], s40 offen sc1
s_waitcnt vmcnt(0)
s_branch QKV_OOLEND
QKV_DOVM:
s_waitcnt vmcnt(0)
s_branch QKV_NOVM
QKV_OOLEND:
s_barrier
s_branch MEGA_ATT
MEGA_PROD0:
s_cmp_lg_u32 s3, 4
s_cbranch_scc1 NONCE_NW4
s_mov_b32 s52, s82
s_mov_b32 s53, s83
s_memrealtime s[54:55]
s_waitcnt lgkmcnt(0)
s_or_b32 s90, s54, 0x10
s_and_b32 s90, s90, 0xfffffff0
v_mov_b32 v250, s90
v_mov_b32 v251, 0
s_cmp_lg_u32 s2, 0
s_cbranch_scc1 NONCE_RD
s_mov_b64 exec, 1
global_store_dword v251, v250, s[52:53] sc1
s_mov_b64 exec, -1
NONCE_RD:
NONCE_NW4:
s_mov_b32 s4, s66
s_mov_b32 s5, s67
s_mov_b32 s6, s84
s_mov_b32 s7, s85
s_mov_b32 s8, s64
s_mov_b32 s9, s65
s_and_b32 s40, s2, 7
s_lshr_b32 s41, s2, 3
s_and_b32 s12, s40, 1
s_lshl_b32 s12, s12, 3
s_and_b32 s42, s41, 7
s_add_u32 s12, s12, s42
s_lshr_b32 s13, s40, 1
s_lshl_b32 s13, s13, 2
s_lshr_b32 s42, s41, 3
s_add_u32 s13, s13, s42
s_waitcnt lgkmcnt(0)
s_sub_u32 s44, s3, 4
s_mov_b32 s16, s8
s_mov_b32 s17, s9
s_mov_b32 s18, 4194304
s_mov_b32 s19, 0x20000
v_lshrrev_b32 v240, 3, v2
v_and_b32 v241, 7, v2
v_lshrrev_b32 v242, 4, v2
s_lshl_b32 s34, s44, 5
v_add_u32 v243, 0, v242
v_and_b32 v243, 7, v243
v_xor_b32 v243, v243, v241
v_add_u32 v244, s34, v240
v_add_u32 v244, 0, v244
v_lshlrev_b32 v244, 11, v244
v_lshl_add_u32 v244, v243, 4, v244
v_add_u32 v243, 4, v242
v_and_b32 v243, 7, v243
v_xor_b32 v243, v243, v241
v_add_u32 v245, s34, v240
v_add_u32 v245, 8, v245
v_lshlrev_b32 v245, 11, v245
v_lshl_add_u32 v245, v243, 4, v245
v_add_u32 v243, 8, v242
v_and_b32 v243, 7, v243
v_xor_b32 v243, v243, v241
v_add_u32 v246, s34, v240
v_add_u32 v246, 16, v246
v_lshlrev_b32 v246, 11, v246
v_lshl_add_u32 v246, v243, 4, v246
v_add_u32 v243, 12, v242
v_and_b32 v243, 7, v243
v_xor_b32 v243, v243, v241
v_add_u32 v247, s34, v240
v_add_u32 v247, 24, v247
v_lshlrev_b32 v247, 11, v247
v_lshl_add_u32 v247, v243, 4, v247
s_lshl_b32 s32, s12, 18
s_mov_b32 s20, s4
s_mov_b32 s21, s5
s_mov_b32 s22, 6291456
s_mov_b32 s23, 0x20000
s_lshl_b32 s33, s44, 12
v_bfe_u32 v240, v2, 2, 2
v_and_b32 v241, 3, v2
v_lshrrev_b32 v242, 4, v2
s_mov_b32 s34, 6144
v_lshrrev_b32 v243, 1, v242
v_lshl_add_u32 v240, v243, 2, v240
v_and_b32 v242, 1, v242
v_mul_lo_u32 v240, v240, s34
v_lshl_add_u32 v240, v241, 4, v240
v_lshl_add_u32 v240, v242, 6, v240
s_mul_i32 s35, s44, 98304
s_lshl_b32 s36, s13, 7
s_add_u32 s37, s36, 2048
s_add_u32 s38, s36, 4096
v_xor_b32 v241, 32, v240
s_add_u32 s40, s35, s36
v_add_u32 v230, s40, v240
s_add_u32 s40, s35, s36
s_add_u32 s40, s40, 49152
v_add_u32 v231, s40, v241
s_add_u32 s40, s35, s37
v_add_u32 v232, s40, v240
s_add_u32 s40, s35, s37
s_add_u32 s40, s40, 49152
v_add_u32 v233, s40, v241
s_add_u32 s40, s35, s38
v_add_u32 v234, s40, v240
s_add_u32 s40, s35, s38
s_add_u32 s40, s40, 49152
v_add_u32 v235, s40, v241
s_lshl_b32 s41, s44, 11
s_add_u32 s41, s41, 16384
s_mov_b32 s42, 0
s_mul_i32 s43, s12, 393216
s_add_u32 m0, s41, 81920
s_nop 0
buffer_load_dwordx4 v230, s[20:23], s43 offen lds
s_add_u32 m0, s41, 82944
s_nop 0
buffer_load_dwordx4 v231, s[20:23], s43 offen lds
s_add_u32 m0, s41, 90112
s_nop 0
buffer_load_dwordx4 v232, s[20:23], s43 offen lds
s_add_u32 m0, s41, 91136
s_nop 0
buffer_load_dwordx4 v233, s[20:23], s43 offen lds
s_add_u32 m0, s41, 98304
s_nop 0
buffer_load_dwordx4 v234, s[20:23], s43 offen lds
s_add_u32 m0, s41, 99328
s_nop 0
buffer_load_dwordx4 v235, s[20:23], s43 offen lds
s_add_u32 m0, s33, 0
s_nop 0
buffer_load_dwordx4 v244, s[16:19], s32 offen lds
s_add_u32 m0, s33, 1024
s_nop 0
buffer_load_dwordx4 v245, s[16:19], s32 offen lds
s_add_u32 m0, s33, 2048
s_nop 0
buffer_load_dwordx4 v246, s[16:19], s32 offen lds
s_add_u32 m0, s33, 3072
s_nop 0
buffer_load_dwordx4 v247, s[16:19], s32 offen lds
s_add_u32 s32, s32, 128
s_add_u32 m0, s41, 0
s_nop 0
buffer_load_dwordx4 v230, s[20:23], s42 offen lds
s_add_u32 m0, s41, 1024
s_nop 0
buffer_load_dwordx4 v231, s[20:23], s42 offen lds
s_add_u32 m0, s41, 8192
s_nop 0
buffer_load_dwordx4 v232, s[20:23], s42 offen lds
s_add_u32 m0, s41, 9216
s_nop 0
buffer_load_dwordx4 v233, s[20:23], s42 offen lds
s_add_u32 m0, s41, 16384
s_nop 0
buffer_load_dwordx4 v234, s[20:23], s42 offen lds
s_add_u32 m0, s41, 17408
s_nop 0
buffer_load_dwordx4 v235, s[20:23], s42 offen lds
s_add_u32 s42, s42, 393216
s_cmp_lg_u32 s3, 4
s_cbranch_scc1 NONCEI_NW4
s_mov_b32 s52, s82
s_mov_b32 s53, s83
v_mov_b32 v251, 0
global_load_dword v250, v251, s[52:53] sc1
NONCEI_NW4:
s_waitcnt vmcnt(10)
s_barrier
s_add_u32 m0, s33, 40960
s_nop 0
buffer_load_dwordx4 v244, s[16:19], s32 offen lds
s_add_u32 m0, s33, 41984
s_nop 0
buffer_load_dwordx4 v245, s[16:19], s32 offen lds
s_add_u32 m0, s33, 43008
s_nop 0
buffer_load_dwordx4 v246, s[16:19], s32 offen lds
s_add_u32 m0, s33, 44032
s_nop 0
buffer_load_dwordx4 v247, s[16:19], s32 offen lds
s_add_u32 s32, s32, 128
s_add_u32 m0, s41, 40960
s_nop 0
buffer_load_dwordx4 v230, s[20:23], s42 offen lds
s_add_u32 m0, s41, 41984
s_nop 0
buffer_load_dwordx4 v231, s[20:23], s42 offen lds
s_add_u32 m0, s41, 49152
s_nop 0
buffer_load_dwordx4 v232, s[20:23], s42 offen lds
s_add_u32 m0, s41, 50176
s_nop 0
buffer_load_dwordx4 v233, s[20:23], s42 offen lds
s_add_u32 m0, s41, 57344
s_nop 0
buffer_load_dwordx4 v234, s[20:23], s42 offen lds
s_add_u32 m0, s41, 58368
s_nop 0
buffer_load_dwordx4 v235, s[20:23], s42 offen lds
s_add_u32 s42, s42, 393216
s_waitcnt vmcnt(10)
s_mov_b32 s14, 0
s_barrier
s_add_u32 m0, s33, 81920
s_nop 0
buffer_load_dwordx4 v244, s[16:19], s32 offen lds
s_add_u32 m0, s33, 82944
s_nop 0
buffer_load_dwordx4 v245, s[16:19], s32 offen lds
s_add_u32 m0, s33, 83968
s_nop 0
buffer_load_dwordx4 v246, s[16:19], s32 offen lds
s_add_u32 m0, s33, 84992
s_nop 0
buffer_load_dwordx4 v247, s[16:19], s32 offen lds
s_add_u32 s32, s32, 128
s_add_u32 m0, s41, 81920
s_nop 0
buffer_load_dwordx4 v230, s[20:23], s42 offen lds
s_add_u32 m0, s41, 82944
s_nop 0
buffer_load_dwordx4 v231, s[20:23], s42 offen lds
s_add_u32 m0, s41, 90112
s_nop 0
buffer_load_dwordx4 v232, s[20:23], s42 offen lds
s_add_u32 m0, s41, 91136
s_nop 0
buffer_load_dwordx4 v233, s[20:23], s42 offen lds
s_add_u32 m0, s41, 98304
s_nop 0
buffer_load_dwordx4 v234, s[20:23], s42 offen lds
s_add_u32 m0, s41, 99328
s_nop 0
buffer_load_dwordx4 v235, s[20:23], s42 offen lds
s_add_u32 s42, s42, 393216
s_waitcnt vmcnt(10)
s_barrier
s_add_u32 s45, s14, s33
s_add_u32 s43, s14, s41
s_add_u32 m0, s45, 0
s_nop 0
buffer_load_dwordx4 v244, s[16:19], s32 offen lds
s_add_u32 m0, s45, 1024
s_nop 0
buffer_load_dwordx4 v245, s[16:19], s32 offen lds
s_add_u32 m0, s45, 2048
s_nop 0
buffer_load_dwordx4 v246, s[16:19], s32 offen lds
s_add_u32 m0, s45, 3072
s_nop 0
buffer_load_dwordx4 v247, s[16:19], s32 offen lds
s_add_u32 s32, s32, 128
s_add_u32 m0, s43, 0
s_nop 0
buffer_load_dwordx4 v230, s[20:23], s42 offen lds
s_add_u32 m0, s43, 1024
s_nop 0
buffer_load_dwordx4 v231, s[20:23], s42 offen lds
s_add_u32 m0, s43, 8192
s_nop 0
buffer_load_dwordx4 v232, s[20:23], s42 offen lds
s_add_u32 m0, s43, 9216
s_nop 0
buffer_load_dwordx4 v233, s[20:23], s42 offen lds
s_add_u32 m0, s43, 16384
s_nop 0
buffer_load_dwordx4 v234, s[20:23], s42 offen lds
s_add_u32 m0, s43, 17408
s_nop 0
buffer_load_dwordx4 v235, s[20:23], s42 offen lds
s_add_u32 s42, s42, 393216
s_add_u32 s14, s14, 40960
s_cmp_eq_u32 s14, 122880
s_cselect_b32 s14, 0, s14
s_waitcnt vmcnt(10)
s_barrier
s_add_u32 s45, s14, s33
s_add_u32 s43, s14, s41
s_add_u32 m0, s45, 0
s_nop 0
buffer_load_dwordx4 v244, s[16:19], s32 offen lds
s_add_u32 m0, s45, 1024
s_nop 0
buffer_load_dwordx4 v245, s[16:19], s32 offen lds
s_add_u32 m0, s45, 2048
s_nop 0
buffer_load_dwordx4 v246, s[16:19], s32 offen lds
s_add_u32 m0, s45, 3072
s_nop 0
buffer_load_dwordx4 v247, s[16:19], s32 offen lds
s_add_u32 s32, s32, 128
s_add_u32 m0, s43, 0
s_nop 0
buffer_load_dwordx4 v230, s[20:23], s42 offen lds
s_add_u32 m0, s43, 1024
s_nop 0
buffer_load_dwordx4 v231, s[20:23], s42 offen lds
s_add_u32 m0, s43, 8192
s_nop 0
buffer_load_dwordx4 v232, s[20:23], s42 offen lds
s_add_u32 m0, s43, 9216
s_nop 0
buffer_load_dwordx4 v233, s[20:23], s42 offen lds
s_add_u32 m0, s43, 16384
s_nop 0
buffer_load_dwordx4 v234, s[20:23], s42 offen lds
s_add_u32 m0, s43, 17408
s_nop 0
buffer_load_dwordx4 v235, s[20:23], s42 offen lds
s_add_u32 s42, s42, 393216
s_add_u32 s14, s14, 40960
s_cmp_eq_u32 s14, 122880
s_cselect_b32 s14, 0, s14
s_waitcnt vmcnt(10)
s_barrier
s_add_u32 s45, s14, s33
s_add_u32 s43, s14, s41
s_add_u32 m0, s45, 0
s_nop 0
buffer_load_dwordx4 v244, s[16:19], s32 offen lds
s_add_u32 m0, s45, 1024
s_nop 0
buffer_load_dwordx4 v245, s[16:19], s32 offen lds
s_add_u32 m0, s45, 2048
s_nop 0
buffer_load_dwordx4 v246, s[16:19], s32 offen lds
s_add_u32 m0, s45, 3072
s_nop 0
buffer_load_dwordx4 v247, s[16:19], s32 offen lds
s_add_u32 s32, s32, 128
s_add_u32 m0, s43, 0
s_nop 0
buffer_load_dwordx4 v230, s[20:23], s42 offen lds
s_add_u32 m0, s43, 1024
s_nop 0
buffer_load_dwordx4 v231, s[20:23], s42 offen lds
s_add_u32 m0, s43, 8192
s_nop 0
buffer_load_dwordx4 v232, s[20:23], s42 offen lds
s_add_u32 m0, s43, 9216
s_nop 0
buffer_load_dwordx4 v233, s[20:23], s42 offen lds
s_add_u32 m0, s43, 16384
s_nop 0
buffer_load_dwordx4 v234, s[20:23], s42 offen lds
s_add_u32 m0, s43, 17408
s_nop 0
buffer_load_dwordx4 v235, s[20:23], s42 offen lds
s_add_u32 s42, s42, 393216
s_add_u32 s14, s14, 40960
s_cmp_eq_u32 s14, 122880
s_cselect_b32 s14, 0, s14
s_cmp_lg_u32 s3, 4
s_cbranch_scc1 SF0_NW4
s_mov_b32 s52, s82
s_mov_b32 s53, s83
v_mov_b32 v251, 0
s_mov_b32 s46, 0
s_waitcnt lgkmcnt(0)
s_waitcnt vmcnt(10)
s_branch NONCE_CHK
NONCE_POLL:
global_load_dword v250, v251, s[52:53] sc1
s_waitcnt vmcnt(0)
NONCE_CHK:
v_readfirstlane_b32 s90, v250
s_add_u32 s46, s46, 1
s_cmp_gt_u32 s46, 400000
s_cbranch_scc1 NONCE_OK
s_cmp_eq_u32 s90, 0
s_cbranch_scc1 NONCE_POLL
NONCE_OK:
s_mov_b32 s48, s6
s_mov_b32 s49, s7
s_add_u32 s48, s48, 50331648
s_addc_u32 s49, s49, 0
s_mov_b32 s50, 262144
s_mov_b32 s51, 0x20000
s_lshl_b32 s46, s12, 4
s_add_u32 s46, s46, s13
s_add_u32 s46, s46, 0
s_lshl_b32 s46, s46, 7
s_add_u32 s47, s90, 0
v_mov_b32 v250, s47
v_mov_b32 v251, 0
s_mov_b64 exec, 1
buffer_store_dword v250, v251, s[48:51], s46 offen sc1
s_mov_b64 exec, -1
SF0_NW4:
s_mov_b32 s15, 10
QKV_PLOOP:
s_waitcnt vmcnt(10)
s_barrier
s_add_u32 s45, s14, s33
s_add_u32 s43, s14, s41
s_add_u32 m0, s45, 0
s_nop 0
buffer_load_dwordx4 v244, s[16:19], s32 offen lds
s_add_u32 m0, s45, 1024
s_nop 0
buffer_load_dwordx4 v245, s[16:19], s32 offen lds
s_add_u32 m0, s45, 2048
s_nop 0
buffer_load_dwordx4 v246, s[16:19], s32 offen lds
s_add_u32 m0, s45, 3072
s_nop 0
buffer_load_dwordx4 v247, s[16:19], s32 offen lds
s_add_u32 s32, s32, 128
s_add_u32 m0, s43, 0
s_nop 0
buffer_load_dwordx4 v230, s[20:23], s42 offen lds
s_add_u32 m0, s43, 1024
s_nop 0
buffer_load_dwordx4 v231, s[20:23], s42 offen lds
s_add_u32 m0, s43, 8192
s_nop 0
buffer_load_dwordx4 v232, s[20:23], s42 offen lds
s_add_u32 m0, s43, 9216
s_nop 0
buffer_load_dwordx4 v233, s[20:23], s42 offen lds
s_add_u32 m0, s43, 16384
s_nop 0
buffer_load_dwordx4 v234, s[20:23], s42 offen lds
s_add_u32 m0, s43, 17408
s_nop 0
buffer_load_dwordx4 v235, s[20:23], s42 offen lds
s_add_u32 s42, s42, 393216
s_add_u32 s14, s14, 40960
s_cmp_eq_u32 s14, 122880
s_cselect_b32 s14, 0, s14
s_sub_u32 s15, s15, 1
s_cmp_lg_u32 s15, 0
s_cbranch_scc1 QKV_PLOOP
s_cmp_eq_u32 s3, 4
s_cbranch_scc1 QKV_LATE
s_waitcnt vmcnt(10)
s_barrier
s_waitcnt vmcnt(0)
s_barrier
s_barrier
s_barrier
s_branch QKV_LATEEND
QKV_LATE:
s_mov_b32 s48, s6
s_mov_b32 s49, s7
s_add_u32 s48, s48, 50331648
s_addc_u32 s49, s49, 0
s_mov_b32 s50, 262144
s_mov_b32 s51, 0x20000
v_and_b32 v249, 15, v2
s_lshl_b32 s46, s12, 4
v_add_u32 v251, s46, v249
v_lshlrev_b32 v249, 4, v249
v_add_u32 v249, s13, v249
v_and_b32 v248, 16, v2
v_cmp_eq_u32 vcc, 0, v248
s_nop 1
v_cndmask_b32 v251, v249, v251, vcc
v_add_u32 v251, 0, v251
v_lshlrev_b32 v251, 7, v251
buffer_load_dword v250, v251, s[48:51], 0 offen sc1
s_waitcnt vmcnt(10)
s_barrier
s_add_u32 s47, s90, 0
s_mov_b32 s46, 0
QKV_LT_PCHK:
s_waitcnt vmcnt(0)
QKV_LT_PCMP:
v_cmp_ne_u32 vcc, s47, v250
s_add_u32 s46, s46, 1
s_cmp_gt_u32 s46, 400000
s_cbranch_scc1 QKV_LT_PCOK
s_cbranch_vccz QKV_LT_PCOK
buffer_load_dword v250, v251, s[48:51], 0 offen sc1
s_branch QKV_LT_PCHK
QKV_LT_PCOK:
s_mov_b32 s24, s6
s_mov_b32 s25, s7
s_mov_b32 s26, 48234496
s_mov_b32 s27, 0x20000
v_min_u32 v248, 47, v2
v_lshlrev_b32 v248, 4, v248
s_mul_i32 s36, s13, 12288
s_add_u32 s36, s36, 45088768
buffer_load_dwordx4 v[100:103], v248, s[24:27], s36 offen sc1
s_add_u32 s36, s36, 768
buffer_load_dwordx4 v[104:107], v248, s[24:27], s36 offen sc1
s_add_u32 s36, s36, 768
buffer_load_dwordx4 v[108:111], v248, s[24:27], s36 offen sc1
s_add_u32 s36, s36, 768
buffer_load_dwordx4 v[112:115], v248, s[24:27], s36 offen sc1
s_add_u32 s36, s36, 768
buffer_load_dwordx4 v[116:119], v248, s[24:27], s36 offen sc1
s_add_u32 s36, s36, 768
buffer_load_dwordx4 v[120:123], v248, s[24:27], s36 offen sc1
s_add_u32 s36, s36, 768
buffer_load_dwordx4 v[124:127], v248, s[24:27], s36 offen sc1
s_add_u32 s36, s36, 768
buffer_load_dwordx4 v[128:131], v248, s[24:27], s36 offen sc1
s_add_u32 s36, s36, 768
buffer_load_dwordx4 v[132:135], v248, s[24:27], s36 offen sc1
s_add_u32 s36, s36, 768
buffer_load_dwordx4 v[136:139], v248, s[24:27], s36 offen sc1
s_add_u32 s36, s36, 768
buffer_load_dwordx4 v[140:143], v248, s[24:27], s36 offen sc1
s_add_u32 s36, s36, 768
buffer_load_dwordx4 v[144:147], v248, s[24:27], s36 offen sc1
s_add_u32 s36, s36, 768
buffer_load_dwordx4 v[148:151], v248, s[24:27], s36 offen sc1
s_add_u32 s36, s36, 768
buffer_load_dwordx4 v[152:155], v248, s[24:27], s36 offen sc1
s_add_u32 s36, s36, 768
buffer_load_dwordx4 v[156:159], v248, s[24:27], s36 offen sc1
s_add_u32 s36, s36, 768
buffer_load_dwordx4 v[160:163], v248, s[24:27], s36 offen sc1
v_lshlrev_b32 v249, 4, v2
s_lshl_b32 s36, s12, 10
s_add_u32 s36, s36, 44040192
buffer_load_dwordx4 v[164:167], v249, s[24:27], s36 offen sc1
s_barrier
s_barrier
s_waitcnt vmcnt(0)
v_pk_add_f32 v[100:101], v[100:101], v[104:105]
v_pk_add_f32 v[102:103], v[102:103], v[106:107]
v_pk_add_f32 v[100:101], v[100:101], v[108:109]
v_pk_add_f32 v[102:103], v[102:103], v[110:111]
v_pk_add_f32 v[100:101], v[100:101], v[112:113]
v_pk_add_f32 v[102:103], v[102:103], v[114:115]
v_pk_add_f32 v[100:101], v[100:101], v[116:117]
v_pk_add_f32 v[102:103], v[102:103], v[118:119]
v_pk_add_f32 v[100:101], v[100:101], v[120:121]
v_pk_add_f32 v[102:103], v[102:103], v[122:123]
v_pk_add_f32 v[100:101], v[100:101], v[124:125]
v_pk_add_f32 v[102:103], v[102:103], v[126:127]
v_pk_add_f32 v[100:101], v[100:101], v[128:129]
v_pk_add_f32 v[102:103], v[102:103], v[130:131]
v_pk_add_f32 v[100:101], v[100:101], v[132:133]
v_pk_add_f32 v[102:103], v[102:103], v[134:135]
v_pk_add_f32 v[100:101], v[100:101], v[136:137]
v_pk_add_f32 v[102:103], v[102:103], v[138:139]
v_pk_add_f32 v[100:101], v[100:101], v[140:141]
v_pk_add_f32 v[102:103], v[102:103], v[142:143]
v_pk_add_f32 v[100:101], v[100:101], v[144:145]
v_pk_add_f32 v[102:103], v[102:103], v[146:147]
v_pk_add_f32 v[100:101], v[100:101], v[148:149]
v_pk_add_f32 v[102:103], v[102:103], v[150:151]
v_pk_add_f32 v[100:101], v[100:101], v[152:153]
v_pk_add_f32 v[102:103], v[102:103], v[154:155]
v_pk_add_f32 v[100:101], v[100:101], v[156:157]
v_pk_add_f32 v[102:103], v[102:103], v[158:159]
v_pk_add_f32 v[100:101], v[100:101], v[160:161]
v_pk_add_f32 v[102:103], v[102:103], v[162:163]
v_add_u32 v248, 122880, v248
ds_write_b128 v248, v[100:103]
v_mov_b32 v168, v164
v_mov_b32 v169, v166
v_mov_b32 v170, v165
v_mov_b32 v171, v167
v_lshlrev_b32 v249, 3, v2
v_add_u32 v249, 122880, v249
ds_write_b64 v249, v[168:169] offset:1024
ds_write_b64 v249, v[170:171] offset:1536
s_waitcnt lgkmcnt(0)
s_barrier
QKV_LATEEND:
s_barrier
MEGA_ATT:
s_cmp_lg_u32 s3, 4
s_cbranch_scc1 F1_NW4
s_mov_b32 s4, s84
s_mov_b32 s5, s85
s_waitcnt lgkmcnt(0)
s_mov_b32 s48, s4
s_mov_b32 s49, s5
s_add_u32 s48, s48, 50331648
s_addc_u32 s49, s49, 0
s_mov_b32 s50, 262144
s_mov_b32 s51, 0x20000
s_lshl_b32 s46, s12, 4
s_add_u32 s46, s46, s13
s_add_u32 s46, s46, 256
s_lshl_b32 s46, s46, 7
s_add_u32 s47, s90, 1
v_mov_b32 v250, s47
v_mov_b32 v251, 0
s_mov_b64 exec, 1
buffer_store_dword v250, v251, s[48:51], s46 offen sc1
s_mov_b64 exec, -1
s_and_b32 s6, s2, 7
s_lshr_b32 s7, s2, 3
s_lshl_b32 s8, s6, 2
s_lshr_b32 s9, s7, 3
s_add_u32 s8, s8, s9
s_and_b32 s24, s7, 7
s_lshr_b32 s46, s8, 1
s_add_u32 s46, s46, 256
s_lshl_b32 s46, s46, 7
v_min_u32 v251, 15, v2
v_mul_u32_u24 v251, 2048, v251
s_add_u32 s47, s90, 1
s_mov_b32 s45, 0
F1_POLL:
buffer_load_dword v250, v251, s[48:51], s46 offen sc1
s_waitcnt vmcnt(0)
v_cmp_ne_u32 vcc, s47, v250
s_add_u32 s45, s45, 1
s_cmp_gt_u32 s45, 400000
s_cbranch_scc1 F1_POK
s_cbranch_vccnz F1_POLL
F1_POK:
F1_NW4:
s_barrier
s_cmp_ge_u32 s3, 4
s_cbranch_scc1 MEGA_ATTP
s_mov_b32 s4, s84
s_mov_b32 s5, s85
s_and_b32 s6, s2, 7
s_lshr_b32 s7, s2, 3
s_lshl_b32 s8, s6, 2
s_lshr_b32 s9, s7, 3
s_add_u32 s8, s8, s9
s_and_b32 s24, s7, 7
s_mov_b32 s88, s24
s_mov_b32 s89, s8
v_lshlrev_b32 v3, 4, v2
s_lshl_b32 s10, s8, 17
s_mov_b32 s24, s4
s_mov_b32 s25, s5
s_mov_b32 s26, 16777216
s_mov_b32 s27, 0x20000
s_lshl_b32 s9, s88, 3
s_lshl_b32 s11, s3, 1
s_add_u32 s9, s9, s11
s_lshl_b32 s11, s9, 11
s_add_u32 s11, s11, s10
buffer_load_dwordx4 v[8:11], v3, s[24:27], s11 offen offset:0 sc1
buffer_load_dwordx4 v[12:15], v3, s[24:27], s11 offen offset:1024 sc1
buffer_load_dwordx4 v[16:19], v3, s[24:27], s11 offen offset:2048 sc1
buffer_load_dwordx4 v[20:23], v3, s[24:27], s11 offen offset:3072 sc1
v_and_b32 v6, 2, v2
v_bfe_u32 v7, v2, 2, 1
v_mov_b32 v1, 0x3f803f80
v_or_b32 v6, v6, v7
v_cmp_eq_u32 vcc, 0, v6
s_nop 1
v_cndmask_b32 v72, 0, v1, vcc
v_mov_b32 v73, v72
v_and_b32 v6, 2, v2
v_xor_b32 v7, 1, v7
v_or_b32 v6, v6, v7
v_cmp_eq_u32 vcc, 0, v6
s_nop 1
v_cndmask_b32 v74, 0, v1, vcc
v_mov_b32 v75, v74
v_and_b32 v7, 1, v2
v_cmp_eq_u32 vcc, 0, v7
v_mov_b32 v1, 0x44444444
v_mov_b32 v7, 0xeeeeeeee
s_nop 0
v_cndmask_b32 v212, v7, v1, vcc
v_mov_b32 v76, 0
v_mov_b32 v77, 0
v_mov_b32 v78, 0
v_mov_b32 v79, 0
v_mov_b32 v180, 0
v_mov_b32 v181, 0
v_mov_b32 v182, 0
v_mov_b32 v183, 0
v_mov_b32 v184, 0
v_mov_b32 v185, 0
v_mov_b32 v186, 0
v_mov_b32 v187, 0
v_mov_b32 v188, 0
v_mov_b32 v189, 0
v_mov_b32 v190, 0
v_mov_b32 v191, 0
v_mov_b32 v192, 0
v_mov_b32 v193, 0
v_mov_b32 v194, 0
v_mov_b32 v195, 0
v_mov_b32 v56, 0
v_mov_b32 v57, 0
v_mov_b32 v58, 0
v_mov_b32 v59, 0
v_mov_b32 v60, 0
v_mov_b32 v61, 0
v_mov_b32 v62, 0
v_mov_b32 v63, 0
v_mov_b32 v80, 0
v_mov_b32 v81, 0
v_mov_b32 v82, 0
v_mov_b32 v83, 0
v_mov_b32 v196, 0
v_mov_b32 v197, 0
v_mov_b32 v198, 0
v_mov_b32 v199, 0
v_mov_b32 v200, 0
v_mov_b32 v201, 0
v_mov_b32 v202, 0
v_mov_b32 v203, 0
v_mov_b32 v204, 0
v_mov_b32 v205, 0
v_mov_b32 v206, 0
v_mov_b32 v207, 0
v_mov_b32 v208, 0
v_mov_b32 v209, 0
v_mov_b32 v210, 0
v_mov_b32 v211, 0
v_mov_b32 v64, 0
v_mov_b32 v65, 0
v_mov_b32 v66, 0
v_mov_b32 v67, 0
v_mov_b32 v68, 0
v_mov_b32 v69, 0
v_mov_b32 v70, 0
v_mov_b32 v71, 0
v_mov_b32 v48, 0
v_mov_b32 v49, 0
v_mov_b32 v50, 0
v_mov_b32 v51, 0
v_mov_b32 v52, 0
v_mov_b32 v53, 0
v_mov_b32 v54, 0
v_mov_b32 v55, 0
v_mov_b32 v4, v3
v_add_u32 v5, 16384, v3
v_mov_b32 v6, 0
v_mov_b32 v7, 131072
ds_write_b32 v7, v6
s_mov_b32 s23, 0
s_waitcnt vmcnt(0) lgkmcnt(0)
s_barrier
ds_read_b128 v[24:27], v4 offset:0
ds_read_b128 v[28:31], v4 offset:1024
ds_read_b128 v[32:35], v4 offset:2048
ds_read_b128 v[36:39], v4 offset:3072
ds_read_b128 v[40:43], v4 offset:8192
ds_read_b128 v[44:47], v4 offset:9216
s_waitcnt lgkmcnt(4)
v_mfma_f32_32x32x16_bf16 v[84:99], v[24:27], v[8:11], 0
v_mfma_f32_32x32x16_bf16 v[84:99], v[28:31], v[12:15], v[84:99]
v_mfma_f32_32x32x16_bf16 v[116:131], v[24:27], v[16:19], 0
v_mfma_f32_32x32x16_bf16 v[116:131], v[28:31], v[20:23], v[116:131]
s_nop 11
v_max3_f32 v6, v84, v85, v86
v_max3_f32 v6, v6, v87, v88
v_max3_f32 v6, v6, v89, v90
v_max3_f32 v6, v6, v91, v92
v_max3_f32 v6, v6, v93, v94
v_max3_f32 v6, v6, v95, v96
v_max3_f32 v6, v6, v97, v98
v_max_f32 v6, v6, v99
v_mov_b32 v1, v6
s_nop 1
v_permlane32_swap_b32 v6, v1
s_nop 0
v_max_f32 v6, v6, v1
v_sub_f32 v148, 0, v6
v_sub_f32 v149, 0, v6
v_sub_f32 v150, 0, v6
v_sub_f32 v151, 0, v6
v_sub_f32 v152, 0, v6
v_sub_f32 v153, 0, v6
v_sub_f32 v154, 0, v6
v_sub_f32 v155, 0, v6
v_sub_f32 v156, 0, v6
v_sub_f32 v157, 0, v6
v_sub_f32 v158, 0, v6
v_sub_f32 v159, 0, v6
v_sub_f32 v160, 0, v6
v_sub_f32 v161, 0, v6
v_sub_f32 v162, 0, v6
v_sub_f32 v163, 0, v6
v_max3_f32 v7, v116, v117, v118
v_max3_f32 v7, v7, v119, v120
v_max3_f32 v7, v7, v121, v122
v_max3_f32 v7, v7, v123, v124
v_max3_f32 v7, v7, v125, v126
v_max3_f32 v7, v7, v127, v128
v_max3_f32 v7, v7, v129, v130
v_max_f32 v7, v7, v131
v_mov_b32 v1, v7
s_nop 1
v_permlane32_swap_b32 v7, v1
s_nop 0
v_max_f32 v7, v7, v1
v_sub_f32 v164, 0, v7
v_sub_f32 v165, 0, v7
v_sub_f32 v166, 0, v7
v_sub_f32 v167, 0, v7
v_sub_f32 v168, 0, v7
v_sub_f32 v169, 0, v7
v_sub_f32 v170, 0, v7
v_sub_f32 v171, 0, v7
v_sub_f32 v172, 0, v7
v_sub_f32 v173, 0, v7
v_sub_f32 v174, 0, v7
v_sub_f32 v175, 0, v7
v_sub_f32 v176, 0, v7
v_sub_f32 v177, 0, v7
v_sub_f32 v178, 0, v7
v_sub_f32 v179, 0, v7
s_nop 1
v_mfma_f32_32x32x16_bf16 v[84:99], v[24:27], v[8:11], v[148:163]
v_mfma_f32_32x32x16_bf16 v[84:99], v[28:31], v[12:15], v[84:99]
v_mfma_f32_32x32x16_bf16 v[116:131], v[24:27], v[16:19], v[164:179]
v_mfma_f32_32x32x16_bf16 v[116:131], v[28:31], v[20:23], v[116:131]
s_nop 11
s_mov_b32 s28, 15
s_setprio 1
.p2align 4
ATT_LOOP:
s_waitcnt lgkmcnt(1)
v_mfma_f32_32x32x16_bf16 v[100:115], v[32:35], v[8:11], v[148:163]
v_exp_f32 v84, v84
v_exp_f32 v85, v85
v_exp_f32 v86, v86
v_exp_f32 v87, v87
v_smfmac_f32_16x16x64_bf16 v[76:79], v[72:75], v[56:63], v212
ds_read_b128 v[24:27], v4 offset:4096
v_exp_f32 v88, v88
v_cvt_pk_bf16_f32 v56, v84, v85
v_exp_f32 v89, v89
v_cvt_pk_bf16_f32 v57, v86, v87
v_exp_f32 v90, v90
v_mfma_f32_32x32x16_bf16 v[180:195], v[52:55], v[60:63], v[180:195]
v_exp_f32 v91, v91
v_exp_f32 v92, v92
v_cvt_pk_bf16_f32 v58, v88, v89
v_exp_f32 v93, v93
v_cvt_pk_bf16_f32 v59, v90, v91
v_exp_f32 v94, v94
v_exp_f32 v95, v95
v_mfma_f32_32x32x16_bf16 v[180:195], v[40:43], v[56:59], v[180:195]
v_exp_f32 v96, v96
v_cvt_pk_bf16_f32 v60, v92, v93
v_exp_f32 v97, v97
v_cvt_pk_bf16_f32 v61, v94, v95
v_exp_f32 v98, v98
v_mfma_f32_32x32x16_bf16 v[100:115], v[36:39], v[12:15], v[100:115]
ds_read_b128 v[28:31], v4 offset:5120
v_exp_f32 v99, v99
v_exp_f32 v116, v116
v_cvt_pk_bf16_f32 v62, v96, v97
v_exp_f32 v117, v117
v_cvt_pk_bf16_f32 v63, v98, v99
v_mfma_f32_32x32x16_bf16 v[132:147], v[32:35], v[16:19], v[164:179]
ds_read_b128 v[48:51], v4 offset:10240
v_exp_f32 v118, v118
v_exp_f32 v119, v119
v_exp_f32 v120, v120
v_smfmac_f32_16x16x64_bf16 v[80:83], v[72:75], v[64:71], v212
v_cvt_pk_bf16_f32 v64, v116, v117
v_exp_f32 v121, v121
v_cvt_pk_bf16_f32 v65, v118, v119
v_exp_f32 v122, v122
v_exp_f32 v123, v123
v_mfma_f32_32x32x16_bf16 v[196:211], v[52:55], v[68:71], v[196:211]
v_exp_f32 v124, v124
v_cvt_pk_bf16_f32 v66, v120, v121
v_exp_f32 v125, v125
v_cvt_pk_bf16_f32 v67, v122, v123
v_exp_f32 v126, v126
v_exp_f32 v127, v127
v_mfma_f32_32x32x16_bf16 v[196:211], v[40:43], v[64:67], v[196:211]
v_exp_f32 v128, v128
v_cvt_pk_bf16_f32 v68, v124, v125
v_exp_f32 v129, v129
v_cvt_pk_bf16_f32 v69, v126, v127
v_mfma_f32_32x32x16_bf16 v[132:147], v[36:39], v[20:23], v[132:147]
ds_read_b128 v[52:55], v4 offset:11264
v_exp_f32 v130, v130
v_exp_f32 v131, v131
v_cvt_pk_bf16_f32 v70, v128, v129
v_cvt_pk_bf16_f32 v71, v130, v131
s_waitcnt lgkmcnt(1)
v_mfma_f32_32x32x16_bf16 v[84:99], v[24:27], v[8:11], v[148:163]
v_exp_f32 v100, v100
v_exp_f32 v101, v101
v_exp_f32 v102, v102
v_exp_f32 v103, v103
v_smfmac_f32_16x16x64_bf16 v[76:79], v[72:75], v[56:63], v212
ds_read_b128 v[32:35], v4 offset:6144
v_exp_f32 v104, v104
v_cvt_pk_bf16_f32 v56, v100, v101
v_exp_f32 v105, v105
v_cvt_pk_bf16_f32 v57, v102, v103
v_exp_f32 v106, v106
v_mfma_f32_32x32x16_bf16 v[180:195], v[44:47], v[60:63], v[180:195]
v_exp_f32 v107, v107
v_exp_f32 v108, v108
v_cvt_pk_bf16_f32 v58, v104, v105
v_exp_f32 v109, v109
v_cvt_pk_bf16_f32 v59, v106, v107
v_exp_f32 v110, v110
v_exp_f32 v111, v111
v_mfma_f32_32x32x16_bf16 v[180:195], v[48:51], v[56:59], v[180:195]
v_exp_f32 v112, v112
v_cvt_pk_bf16_f32 v60, v108, v109
v_exp_f32 v113, v113
v_cvt_pk_bf16_f32 v61, v110, v111
v_exp_f32 v114, v114
v_mfma_f32_32x32x16_bf16 v[84:99], v[28:31], v[12:15], v[84:99]
ds_read_b128 v[36:39], v4 offset:7168
v_exp_f32 v115, v115
v_exp_f32 v132, v132
v_cvt_pk_bf16_f32 v62, v112, v113
v_exp_f32 v133, v133
v_cvt_pk_bf16_f32 v63, v114, v115
v_mfma_f32_32x32x16_bf16 v[116:131], v[24:27], v[16:19], v[164:179]
ds_read_b128 v[40:43], v4 offset:12288
v_exp_f32 v134, v134
v_exp_f32 v135, v135
v_exp_f32 v136, v136
v_smfmac_f32_16x16x64_bf16 v[80:83], v[72:75], v[64:71], v212
v_cvt_pk_bf16_f32 v64, v132, v133
v_exp_f32 v137, v137
v_cvt_pk_bf16_f32 v65, v134, v135
v_exp_f32 v138, v138
v_exp_f32 v139, v139
v_mfma_f32_32x32x16_bf16 v[196:211], v[44:47], v[68:71], v[196:211]
v_exp_f32 v140, v140
v_cvt_pk_bf16_f32 v66, v136, v137
v_exp_f32 v141, v141
v_cvt_pk_bf16_f32 v67, v138, v139
v_exp_f32 v142, v142
v_exp_f32 v143, v143
v_mfma_f32_32x32x16_bf16 v[196:211], v[48:51], v[64:67], v[196:211]
v_exp_f32 v144, v144
v_cvt_pk_bf16_f32 v68, v140, v141
v_exp_f32 v145, v145
v_cvt_pk_bf16_f32 v69, v142, v143
v_mfma_f32_32x32x16_bf16 v[116:131], v[28:31], v[20:23], v[116:131]
ds_read_b128 v[44:47], v4 offset:13312
v_exp_f32 v146, v146
v_exp_f32 v147, v147
v_cvt_pk_bf16_f32 v70, v144, v145
v_cvt_pk_bf16_f32 v71, v146, v147
s_waitcnt lgkmcnt(1)
v_mfma_f32_32x32x16_bf16 v[100:115], v[32:35], v[8:11], v[148:163]
v_exp_f32 v84, v84
v_exp_f32 v85, v85
s_barrier
v_exp_f32 v86, v86
v_exp_f32 v87, v87
v_smfmac_f32_16x16x64_bf16 v[76:79], v[72:75], v[56:63], v212
ds_read_b128 v[24:27], v5 offset:0
v_exp_f32 v88, v88
v_cvt_pk_bf16_f32 v56, v84, v85
v_exp_f32 v89, v89
v_cvt_pk_bf16_f32 v57, v86, v87
v_exp_f32 v90, v90
v_mfma_f32_32x32x16_bf16 v[180:195], v[52:55], v[60:63], v[180:195]
v_exp_f32 v91, v91
v_exp_f32 v92, v92
v_cvt_pk_bf16_f32 v58, v88, v89
v_exp_f32 v93, v93
v_cvt_pk_bf16_f32 v59, v90, v91
v_exp_f32 v94, v94
v_exp_f32 v95, v95
v_mfma_f32_32x32x16_bf16 v[180:195], v[40:43], v[56:59], v[180:195]
v_exp_f32 v96, v96
v_cvt_pk_bf16_f32 v60, v92, v93
v_exp_f32 v97, v97
v_cvt_pk_bf16_f32 v61, v94, v95
v_exp_f32 v98, v98
v_mfma_f32_32x32x16_bf16 v[100:115], v[36:39], v[12:15], v[100:115]
ds_read_b128 v[28:31], v5 offset:1024
v_exp_f32 v99, v99
v_exp_f32 v116, v116
v_cvt_pk_bf16_f32 v62, v96, v97
v_exp_f32 v117, v117
v_cvt_pk_bf16_f32 v63, v98, v99
v_mfma_f32_32x32x16_bf16 v[132:147], v[32:35], v[16:19], v[164:179]
ds_read_b128 v[48:51], v4 offset:14336
v_exp_f32 v118, v118
v_exp_f32 v119, v119
v_exp_f32 v120, v120
v_smfmac_f32_16x16x64_bf16 v[80:83], v[72:75], v[64:71], v212
v_cvt_pk_bf16_f32 v64, v116, v117
v_exp_f32 v121, v121
v_cvt_pk_bf16_f32 v65, v118, v119
v_exp_f32 v122, v122
v_exp_f32 v123, v123
v_mfma_f32_32x32x16_bf16 v[196:211], v[52:55], v[68:71], v[196:211]
v_exp_f32 v124, v124
v_cvt_pk_bf16_f32 v66, v120, v121
v_exp_f32 v125, v125
v_cvt_pk_bf16_f32 v67, v122, v123
v_exp_f32 v126, v126
v_exp_f32 v127, v127
v_mfma_f32_32x32x16_bf16 v[196:211], v[40:43], v[64:67], v[196:211]
v_exp_f32 v128, v128
v_cvt_pk_bf16_f32 v68, v124, v125
v_exp_f32 v129, v129
v_cvt_pk_bf16_f32 v69, v126, v127
v_mfma_f32_32x32x16_bf16 v[132:147], v[36:39], v[20:23], v[132:147]
ds_read_b128 v[52:55], v4 offset:15360
v_exp_f32 v130, v130
v_exp_f32 v131, v131
v_cvt_pk_bf16_f32 v70, v128, v129
v_cvt_pk_bf16_f32 v71, v130, v131
s_waitcnt lgkmcnt(1)
v_mfma_f32_32x32x16_bf16 v[84:99], v[24:27], v[8:11], v[148:163]
v_exp_f32 v100, v100
v_exp_f32 v101, v101
v_exp_f32 v102, v102
v_exp_f32 v103, v103
v_smfmac_f32_16x16x64_bf16 v[76:79], v[72:75], v[56:63], v212
ds_read_b128 v[32:35], v5 offset:2048
v_exp_f32 v104, v104
v_cvt_pk_bf16_f32 v56, v100, v101
v_exp_f32 v105, v105
v_cvt_pk_bf16_f32 v57, v102, v103
v_exp_f32 v106, v106
v_mfma_f32_32x32x16_bf16 v[180:195], v[44:47], v[60:63], v[180:195]
v_exp_f32 v107, v107
v_exp_f32 v108, v108
v_cvt_pk_bf16_f32 v58, v104, v105
v_exp_f32 v109, v109
v_cvt_pk_bf16_f32 v59, v106, v107
v_exp_f32 v110, v110
v_exp_f32 v111, v111
v_mfma_f32_32x32x16_bf16 v[180:195], v[48:51], v[56:59], v[180:195]
v_exp_f32 v112, v112
v_cvt_pk_bf16_f32 v60, v108, v109
v_exp_f32 v113, v113
v_cvt_pk_bf16_f32 v61, v110, v111
v_exp_f32 v114, v114
v_mfma_f32_32x32x16_bf16 v[84:99], v[28:31], v[12:15], v[84:99]
ds_read_b128 v[36:39], v5 offset:3072
v_exp_f32 v115, v115
v_exp_f32 v132, v132
v_cvt_pk_bf16_f32 v62, v112, v113
v_exp_f32 v133, v133
v_cvt_pk_bf16_f32 v63, v114, v115
v_mfma_f32_32x32x16_bf16 v[116:131], v[24:27], v[16:19], v[164:179]
ds_read_b128 v[40:43], v5 offset:8192
v_exp_f32 v134, v134
v_exp_f32 v135, v135
v_exp_f32 v136, v136
v_smfmac_f32_16x16x64_bf16 v[80:83], v[72:75], v[64:71], v212
v_cvt_pk_bf16_f32 v64, v132, v133
v_exp_f32 v137, v137
v_cvt_pk_bf16_f32 v65, v134, v135
v_exp_f32 v138, v138
v_exp_f32 v139, v139
v_mfma_f32_32x32x16_bf16 v[196:211], v[44:47], v[68:71], v[196:211]
v_exp_f32 v140, v140
v_cvt_pk_bf16_f32 v66, v136, v137
v_exp_f32 v141, v141
v_cvt_pk_bf16_f32 v67, v138, v139
v_exp_f32 v142, v142
v_exp_f32 v143, v143
v_mfma_f32_32x32x16_bf16 v[196:211], v[48:51], v[64:67], v[196:211]
v_exp_f32 v144, v144
v_cvt_pk_bf16_f32 v68, v140, v141
v_exp_f32 v145, v145
v_cvt_pk_bf16_f32 v69, v142, v143
v_mfma_f32_32x32x16_bf16 v[116:131], v[28:31], v[20:23], v[116:131]
ds_read_b128 v[44:47], v5 offset:9216
v_exp_f32 v146, v146
v_exp_f32 v147, v147
v_cvt_pk_bf16_f32 v70, v144, v145
v_cvt_pk_bf16_f32 v71, v146, v147
v_mov_b32 v4, v5
v_add_u32 v5, 16384, v5
s_sub_u32 s28, s28, 1
v_and_b32 v5, 131071, v5
s_cbranch_scc0 ATT_LOOP
s_setprio 0
s_nop 1
v_mfma_f32_32x32x16_bf16 v[180:195], v[52:55], v[60:63], v[180:195]
v_smfmac_f32_16x16x64_bf16 v[76:79], v[72:75], v[56:63], v212
v_mfma_f32_32x32x16_bf16 v[196:211], v[52:55], v[68:71], v[196:211]
v_smfmac_f32_16x16x64_bf16 v[80:83], v[72:75], v[64:71], v212
s_waitcnt lgkmcnt(0)
s_nop 11
v_add_f32 v76, v76, v77
v_add_f32 v80, v80, v81
s_mov_b32 s30, 0x5d800000
v_max_f32 v6, v76, v80
v_cmp_gt_f32 vcc, s30, v6
v_cmp_gt_f32 s[42:43], s30, v76
v_cmp_gt_f32 s[44:45], s30, v80
s_nop 3
s_and_b64 s[42:43], s[42:43], s[44:45]
s_cmp_eq_u64 s[42:43], exec
s_cbranch_scc1 ATT_OK
v_mov_b32 v6, 1
v_mov_b32 v7, 131072
ds_write_b32 v7, v6
ATT_OK:
s_waitcnt lgkmcnt(0)
s_barrier
v_mov_b32 v7, 131072
ds_read_b32 v6, v7
s_waitcnt lgkmcnt(0)
v_readfirstlane_b32 s30, v6
s_nop 1
s_cmp_eq_u32 s30, 0
s_cbranch_scc1 ATT_FIN
v_mov_b32 v76, 0
v_mov_b32 v77, 0
v_mov_b32 v78, 0
v_mov_b32 v79, 0
v_mov_b32 v180, 0
v_mov_b32 v181, 0
v_mov_b32 v182, 0
v_mov_b32 v183, 0
v_mov_b32 v184, 0
v_mov_b32 v185, 0
v_mov_b32 v186, 0
v_mov_b32 v187, 0
v_mov_b32 v188, 0
v_mov_b32 v189, 0
v_mov_b32 v190, 0
v_mov_b32 v191, 0
v_mov_b32 v192, 0
v_mov_b32 v193, 0
v_mov_b32 v194, 0
v_mov_b32 v195, 0
v_mov_b32 v148, 0xff7fffff
v_mov_b32 v80, 0
v_mov_b32 v81, 0
v_mov_b32 v82, 0
v_mov_b32 v83, 0
v_mov_b32 v196, 0
v_mov_b32 v197, 0
v_mov_b32 v198, 0
v_mov_b32 v199, 0
v_mov_b32 v200, 0
v_mov_b32 v201, 0
v_mov_b32 v202, 0
v_mov_b32 v203, 0
v_mov_b32 v204, 0
v_mov_b32 v205, 0
v_mov_b32 v206, 0
v_mov_b32 v207, 0
v_mov_b32 v208, 0
v_mov_b32 v209, 0
v_mov_b32 v210, 0
v_mov_b32 v211, 0
v_mov_b32 v164, 0xff7fffff
s_mov_b32 s28, 16
v_mov_b32 v4, v3
ATT_SLOW:
s_barrier
ds_read_b128 v[24:27], v4 offset:0
ds_read_b128 v[28:31], v4 offset:1024
ds_read_b128 v[40:43], v4 offset:8192
ds_read_b128 v[44:47], v4 offset:9216
s_waitcnt lgkmcnt(0)
v_mfma_f32_32x32x16_bf16 v[84:99], v[24:27], v[8:11], 0
v_mfma_f32_32x32x16_bf16 v[84:99], v[28:31], v[12:15], v[84:99]
s_nop 11
v_max3_f32 v7, v84, v85, v86
v_max3_f32 v7, v7, v87, v88
v_max3_f32 v7, v7, v89, v90
v_max3_f32 v7, v7, v91, v92
v_max3_f32 v7, v7, v93, v94
v_max3_f32 v7, v7, v95, v96
v_max3_f32 v7, v7, v97, v98
v_max3_f32 v7, v7, v99, v148
v_mov_b32 v1, v7
s_nop 1
v_permlane32_swap_b32 v7, v1
s_nop 0
v_max_f32 v7, v7, v1
v_sub_f32 v1, v148, v7
v_exp_f32 v1, v1
v_mov_b32 v148, v7
v_sub_f32 v84, v84, v7
v_sub_f32 v85, v85, v7
v_sub_f32 v86, v86, v7
v_sub_f32 v87, v87, v7
v_sub_f32 v88, v88, v7
v_sub_f32 v89, v89, v7
v_sub_f32 v90, v90, v7
v_sub_f32 v91, v91, v7
v_sub_f32 v92, v92, v7
v_sub_f32 v93, v93, v7
v_sub_f32 v94, v94, v7
v_sub_f32 v95, v95, v7
v_sub_f32 v96, v96, v7
v_sub_f32 v97, v97, v7
v_sub_f32 v98, v98, v7
v_sub_f32 v99, v99, v7
v_exp_f32 v84, v84
v_exp_f32 v85, v85
v_exp_f32 v86, v86
v_exp_f32 v87, v87
v_exp_f32 v88, v88
v_exp_f32 v89, v89
v_exp_f32 v90, v90
v_exp_f32 v91, v91
v_exp_f32 v92, v92
v_exp_f32 v93, v93
v_exp_f32 v94, v94
v_exp_f32 v95, v95
v_exp_f32 v96, v96
v_exp_f32 v97, v97
v_exp_f32 v98, v98
v_exp_f32 v99, v99
v_mul_f32 v180, v180, v1
v_mul_f32 v181, v181, v1
v_mul_f32 v182, v182, v1
v_mul_f32 v183, v183, v1
v_mul_f32 v184, v184, v1
v_mul_f32 v185, v185, v1
v_mul_f32 v186, v186, v1
v_mul_f32 v187, v187, v1
v_mul_f32 v188, v188, v1
v_mul_f32 v189, v189, v1
v_mul_f32 v190, v190, v1
v_mul_f32 v191, v191, v1
v_mul_f32 v192, v192, v1
v_mul_f32 v193, v193, v1
v_mul_f32 v194, v194, v1
v_mul_f32 v195, v195, v1
v_mul_f32 v76, v76, v1
v_mul_f32 v77, v77, v1
v_mul_f32 v78, v78, v1
v_mul_f32 v79, v79, v1
v_cvt_pk_bf16_f32 v56, v84, v85
v_cvt_pk_bf16_f32 v57, v86, v87
v_cvt_pk_bf16_f32 v58, v88, v89
v_cvt_pk_bf16_f32 v59, v90, v91
v_cvt_pk_bf16_f32 v60, v92, v93
v_cvt_pk_bf16_f32 v61, v94, v95
v_cvt_pk_bf16_f32 v62, v96, v97
v_cvt_pk_bf16_f32 v63, v98, v99
s_nop 1
v_mfma_f32_32x32x16_bf16 v[180:195], v[40:43], v[56:59], v[180:195]
v_mfma_f32_32x32x16_bf16 v[180:195], v[44:47], v[60:63], v[180:195]
v_smfmac_f32_16x16x64_bf16 v[76:79], v[72:75], v[56:63], v212
s_nop 11
v_mfma_f32_32x32x16_bf16 v[116:131], v[24:27], v[16:19], 0
v_mfma_f32_32x32x16_bf16 v[116:131], v[28:31], v[20:23], v[116:131]
s_nop 11
v_max3_f32 v7, v116, v117, v118
v_max3_f32 v7, v7, v119, v120
v_max3_f32 v7, v7, v121, v122
v_max3_f32 v7, v7, v123, v124
v_max3_f32 v7, v7, v125, v126
v_max3_f32 v7, v7, v127, v128
v_max3_f32 v7, v7, v129, v130
v_max3_f32 v7, v7, v131, v164
v_mov_b32 v1, v7
s_nop 1
v_permlane32_swap_b32 v7, v1
s_nop 0
v_max_f32 v7, v7, v1
v_sub_f32 v1, v164, v7
v_exp_f32 v1, v1
v_mov_b32 v164, v7
v_sub_f32 v116, v116, v7
v_sub_f32 v117, v117, v7
v_sub_f32 v118, v118, v7
v_sub_f32 v119, v119, v7
v_sub_f32 v120, v120, v7
v_sub_f32 v121, v121, v7
v_sub_f32 v122, v122, v7
v_sub_f32 v123, v123, v7
v_sub_f32 v124, v124, v7
v_sub_f32 v125, v125, v7
v_sub_f32 v126, v126, v7
v_sub_f32 v127, v127, v7
v_sub_f32 v128, v128, v7
v_sub_f32 v129, v129, v7
v_sub_f32 v130, v130, v7
v_sub_f32 v131, v131, v7
v_exp_f32 v116, v116
v_exp_f32 v117, v117
v_exp_f32 v118, v118
v_exp_f32 v119, v119
v_exp_f32 v120, v120
v_exp_f32 v121, v121
v_exp_f32 v122, v122
v_exp_f32 v123, v123
v_exp_f32 v124, v124
v_exp_f32 v125, v125
v_exp_f32 v126, v126
v_exp_f32 v127, v127
v_exp_f32 v128, v128
v_exp_f32 v129, v129
v_exp_f32 v130, v130
v_exp_f32 v131, v131
v_mul_f32 v196, v196, v1
v_mul_f32 v197, v197, v1
v_mul_f32 v198, v198, v1
v_mul_f32 v199, v199, v1
v_mul_f32 v200, v200, v1
v_mul_f32 v201, v201, v1
v_mul_f32 v202, v202, v1
v_mul_f32 v203, v203, v1
v_mul_f32 v204, v204, v1
v_mul_f32 v205, v205, v1
v_mul_f32 v206, v206, v1
v_mul_f32 v207, v207, v1
v_mul_f32 v208, v208, v1
v_mul_f32 v209, v209, v1
v_mul_f32 v210, v210, v1
v_mul_f32 v211, v211, v1
v_mul_f32 v80, v80, v1
v_mul_f32 v81, v81, v1
v_mul_f32 v82, v82, v1
v_mul_f32 v83, v83, v1
v_cvt_pk_bf16_f32 v64, v116, v117
v_cvt_pk_bf16_f32 v65, v118, v119
v_cvt_pk_bf16_f32 v66, v120, v121
v_cvt_pk_bf16_f32 v67, v122, v123
v_cvt_pk_bf16_f32 v68, v124, v125
v_cvt_pk_bf16_f32 v69, v126, v127
v_cvt_pk_bf16_f32 v70, v128, v129
v_cvt_pk_bf16_f32 v71, v130, v131
s_nop 1
v_mfma_f32_32x32x16_bf16 v[196:211], v[40:43], v[64:67], v[196:211]
v_mfma_f32_32x32x16_bf16 v[196:211], v[44:47], v[68:71], v[196:211]
v_smfmac_f32_16x16x64_bf16 v[80:83], v[72:75], v[64:71], v212
s_nop 11
ds_read_b128 v[32:35], v4 offset:2048
ds_read_b128 v[36:39], v4 offset:3072
ds_read_b128 v[48:51], v4 offset:10240
ds_read_b128 v[52:55], v4 offset:11264
s_waitcnt lgkmcnt(0)
v_mfma_f32_32x32x16_bf16 v[100:115], v[32:35], v[8:11], 0
v_mfma_f32_32x32x16_bf16 v[100:115], v[36:39], v[12:15], v[100:115]
s_nop 11
v_max3_f32 v7, v100, v101, v102
v_max3_f32 v7, v7, v103, v104
v_max3_f32 v7, v7, v105, v106
v_max3_f32 v7, v7, v107, v108
v_max3_f32 v7, v7, v109, v110
v_max3_f32 v7, v7, v111, v112
v_max3_f32 v7, v7, v113, v114
v_max3_f32 v7, v7, v115, v148
v_mov_b32 v1, v7
s_nop 1
v_permlane32_swap_b32 v7, v1
s_nop 0
v_max_f32 v7, v7, v1
v_sub_f32 v1, v148, v7
v_exp_f32 v1, v1
v_mov_b32 v148, v7
v_sub_f32 v100, v100, v7
v_sub_f32 v101, v101, v7
v_sub_f32 v102, v102, v7
v_sub_f32 v103, v103, v7
v_sub_f32 v104, v104, v7
v_sub_f32 v105, v105, v7
v_sub_f32 v106, v106, v7
v_sub_f32 v107, v107, v7
v_sub_f32 v108, v108, v7
v_sub_f32 v109, v109, v7
v_sub_f32 v110, v110, v7
v_sub_f32 v111, v111, v7
v_sub_f32 v112, v112, v7
v_sub_f32 v113, v113, v7
v_sub_f32 v114, v114, v7
v_sub_f32 v115, v115, v7
v_exp_f32 v100, v100
v_exp_f32 v101, v101
v_exp_f32 v102, v102
v_exp_f32 v103, v103
v_exp_f32 v104, v104
v_exp_f32 v105, v105
v_exp_f32 v106, v106
v_exp_f32 v107, v107
v_exp_f32 v108, v108
v_exp_f32 v109, v109
v_exp_f32 v110, v110
v_exp_f32 v111, v111
v_exp_f32 v112, v112
v_exp_f32 v113, v113
v_exp_f32 v114, v114
v_exp_f32 v115, v115
v_mul_f32 v180, v180, v1
v_mul_f32 v181, v181, v1
v_mul_f32 v182, v182, v1
v_mul_f32 v183, v183, v1
v_mul_f32 v184, v184, v1
v_mul_f32 v185, v185, v1
v_mul_f32 v186, v186, v1
v_mul_f32 v187, v187, v1
v_mul_f32 v188, v188, v1
v_mul_f32 v189, v189, v1
v_mul_f32 v190, v190, v1
v_mul_f32 v191, v191, v1
v_mul_f32 v192, v192, v1
v_mul_f32 v193, v193, v1
v_mul_f32 v194, v194, v1
v_mul_f32 v195, v195, v1
v_mul_f32 v76, v76, v1
v_mul_f32 v77, v77, v1
v_mul_f32 v78, v78, v1
v_mul_f32 v79, v79, v1
v_cvt_pk_bf16_f32 v56, v100, v101
v_cvt_pk_bf16_f32 v57, v102, v103
v_cvt_pk_bf16_f32 v58, v104, v105
v_cvt_pk_bf16_f32 v59, v106, v107
v_cvt_pk_bf16_f32 v60, v108, v109
v_cvt_pk_bf16_f32 v61, v110, v111
v_cvt_pk_bf16_f32 v62, v112, v113
v_cvt_pk_bf16_f32 v63, v114, v115
s_nop 1
v_mfma_f32_32x32x16_bf16 v[180:195], v[48:51], v[56:59], v[180:195]
v_mfma_f32_32x32x16_bf16 v[180:195], v[52:55], v[60:63], v[180:195]
v_smfmac_f32_16x16x64_bf16 v[76:79], v[72:75], v[56:63], v212
s_nop 11
v_mfma_f32_32x32x16_bf16 v[132:147], v[32:35], v[16:19], 0
v_mfma_f32_32x32x16_bf16 v[132:147], v[36:39], v[20:23], v[132:147]
s_nop 11
v_max3_f32 v7, v132, v133, v134
v_max3_f32 v7, v7, v135, v136
v_max3_f32 v7, v7, v137, v138
v_max3_f32 v7, v7, v139, v140
v_max3_f32 v7, v7, v141, v142
v_max3_f32 v7, v7, v143, v144
v_max3_f32 v7, v7, v145, v146
v_max3_f32 v7, v7, v147, v164
v_mov_b32 v1, v7
s_nop 1
v_permlane32_swap_b32 v7, v1
s_nop 0
v_max_f32 v7, v7, v1
v_sub_f32 v1, v164, v7
v_exp_f32 v1, v1
v_mov_b32 v164, v7
v_sub_f32 v132, v132, v7
v_sub_f32 v133, v133, v7
v_sub_f32 v134, v134, v7
v_sub_f32 v135, v135, v7
v_sub_f32 v136, v136, v7
v_sub_f32 v137, v137, v7
v_sub_f32 v138, v138, v7
v_sub_f32 v139, v139, v7
v_sub_f32 v140, v140, v7
v_sub_f32 v141, v141, v7
v_sub_f32 v142, v142, v7
v_sub_f32 v143, v143, v7
v_sub_f32 v144, v144, v7
v_sub_f32 v145, v145, v7
v_sub_f32 v146, v146, v7
v_sub_f32 v147, v147, v7
v_exp_f32 v132, v132
v_exp_f32 v133, v133
v_exp_f32 v134, v134
v_exp_f32 v135, v135
v_exp_f32 v136, v136
v_exp_f32 v137, v137
v_exp_f32 v138, v138
v_exp_f32 v139, v139
v_exp_f32 v140, v140
v_exp_f32 v141, v141
v_exp_f32 v142, v142
v_exp_f32 v143, v143
v_exp_f32 v144, v144
v_exp_f32 v145, v145
v_exp_f32 v146, v146
v_exp_f32 v147, v147
v_mul_f32 v196, v196, v1
v_mul_f32 v197, v197, v1
v_mul_f32 v198, v198, v1
v_mul_f32 v199, v199, v1
v_mul_f32 v200, v200, v1
v_mul_f32 v201, v201, v1
v_mul_f32 v202, v202, v1
v_mul_f32 v203, v203, v1
v_mul_f32 v204, v204, v1
v_mul_f32 v205, v205, v1
v_mul_f32 v206, v206, v1
v_mul_f32 v207, v207, v1
v_mul_f32 v208, v208, v1
v_mul_f32 v209, v209, v1
v_mul_f32 v210, v210, v1
v_mul_f32 v211, v211, v1
v_mul_f32 v80, v80, v1
v_mul_f32 v81, v81, v1
v_mul_f32 v82, v82, v1
v_mul_f32 v83, v83, v1
v_cvt_pk_bf16_f32 v64, v132, v133
v_cvt_pk_bf16_f32 v65, v134, v135
v_cvt_pk_bf16_f32 v66, v136, v137
v_cvt_pk_bf16_f32 v67, v138, v139
v_cvt_pk_bf16_f32 v68, v140, v141
v_cvt_pk_bf16_f32 v69, v142, v143
v_cvt_pk_bf16_f32 v70, v144, v145
v_cvt_pk_bf16_f32 v71, v146, v147
s_nop 1
v_mfma_f32_32x32x16_bf16 v[196:211], v[48:51], v[64:67], v[196:211]
v_mfma_f32_32x32x16_bf16 v[196:211], v[52:55], v[68:71], v[196:211]
v_smfmac_f32_16x16x64_bf16 v[80:83], v[72:75], v[64:71], v212
s_nop 11
ds_read_b128 v[24:27], v4 offset:4096
ds_read_b128 v[28:31], v4 offset:5120
ds_read_b128 v[40:43], v4 offset:12288
ds_read_b128 v[44:47], v4 offset:13312
s_waitcnt lgkmcnt(0)
v_mfma_f32_32x32x16_bf16 v[84:99], v[24:27], v[8:11], 0
v_mfma_f32_32x32x16_bf16 v[84:99], v[28:31], v[12:15], v[84:99]
s_nop 11
v_max3_f32 v7, v84, v85, v86
v_max3_f32 v7, v7, v87, v88
v_max3_f32 v7, v7, v89, v90
v_max3_f32 v7, v7, v91, v92
v_max3_f32 v7, v7, v93, v94
v_max3_f32 v7, v7, v95, v96
v_max3_f32 v7, v7, v97, v98
v_max3_f32 v7, v7, v99, v148
v_mov_b32 v1, v7
s_nop 1
v_permlane32_swap_b32 v7, v1
s_nop 0
v_max_f32 v7, v7, v1
v_sub_f32 v1, v148, v7
v_exp_f32 v1, v1
v_mov_b32 v148, v7
v_sub_f32 v84, v84, v7
v_sub_f32 v85, v85, v7
v_sub_f32 v86, v86, v7
v_sub_f32 v87, v87, v7
v_sub_f32 v88, v88, v7
v_sub_f32 v89, v89, v7
v_sub_f32 v90, v90, v7
v_sub_f32 v91, v91, v7
v_sub_f32 v92, v92, v7
v_sub_f32 v93, v93, v7
v_sub_f32 v94, v94, v7
v_sub_f32 v95, v95, v7
v_sub_f32 v96, v96, v7
v_sub_f32 v97, v97, v7
v_sub_f32 v98, v98, v7
v_sub_f32 v99, v99, v7
v_exp_f32 v84, v84
v_exp_f32 v85, v85
v_exp_f32 v86, v86
v_exp_f32 v87, v87
v_exp_f32 v88, v88
v_exp_f32 v89, v89
v_exp_f32 v90, v90
v_exp_f32 v91, v91
v_exp_f32 v92, v92
v_exp_f32 v93, v93
v_exp_f32 v94, v94
v_exp_f32 v95, v95
v_exp_f32 v96, v96
v_exp_f32 v97, v97
v_exp_f32 v98, v98
v_exp_f32 v99, v99
v_mul_f32 v180, v180, v1
v_mul_f32 v181, v181, v1
v_mul_f32 v182, v182, v1
v_mul_f32 v183, v183, v1
v_mul_f32 v184, v184, v1
v_mul_f32 v185, v185, v1
v_mul_f32 v186, v186, v1
v_mul_f32 v187, v187, v1
v_mul_f32 v188, v188, v1
v_mul_f32 v189, v189, v1
v_mul_f32 v190, v190, v1
v_mul_f32 v191, v191, v1
v_mul_f32 v192, v192, v1
v_mul_f32 v193, v193, v1
v_mul_f32 v194, v194, v1
v_mul_f32 v195, v195, v1
v_mul_f32 v76, v76, v1
v_mul_f32 v77, v77, v1
v_mul_f32 v78, v78, v1
v_mul_f32 v79, v79, v1
v_cvt_pk_bf16_f32 v56, v84, v85
v_cvt_pk_bf16_f32 v57, v86, v87
v_cvt_pk_bf16_f32 v58, v88, v89
v_cvt_pk_bf16_f32 v59, v90, v91
v_cvt_pk_bf16_f32 v60, v92, v93
v_cvt_pk_bf16_f32 v61, v94, v95
v_cvt_pk_bf16_f32 v62, v96, v97
v_cvt_pk_bf16_f32 v63, v98, v99
s_nop 1
v_mfma_f32_32x32x16_bf16 v[180:195], v[40:43], v[56:59], v[180:195]
v_mfma_f32_32x32x16_bf16 v[180:195], v[44:47], v[60:63], v[180:195]
v_smfmac_f32_16x16x64_bf16 v[76:79], v[72:75], v[56:63], v212
s_nop 11
v_mfma_f32_32x32x16_bf16 v[116:131], v[24:27], v[16:19], 0
v_mfma_f32_32x32x16_bf16 v[116:131], v[28:31], v[20:23], v[116:131]
s_nop 11
v_max3_f32 v7, v116, v117, v118
v_max3_f32 v7, v7, v119, v120
v_max3_f32 v7, v7, v121, v122
v_max3_f32 v7, v7, v123, v124
v_max3_f32 v7, v7, v125, v126
v_max3_f32 v7, v7, v127, v128
v_max3_f32 v7, v7, v129, v130
v_max3_f32 v7, v7, v131, v164
v_mov_b32 v1, v7
s_nop 1
v_permlane32_swap_b32 v7, v1
s_nop 0
v_max_f32 v7, v7, v1
v_sub_f32 v1, v164, v7
v_exp_f32 v1, v1
v_mov_b32 v164, v7
v_sub_f32 v116, v116, v7
v_sub_f32 v117, v117, v7
v_sub_f32 v118, v118, v7
v_sub_f32 v119, v119, v7
v_sub_f32 v120, v120, v7
v_sub_f32 v121, v121, v7
v_sub_f32 v122, v122, v7
v_sub_f32 v123, v123, v7
v_sub_f32 v124, v124, v7
v_sub_f32 v125, v125, v7
v_sub_f32 v126, v126, v7
v_sub_f32 v127, v127, v7
v_sub_f32 v128, v128, v7
v_sub_f32 v129, v129, v7
v_sub_f32 v130, v130, v7
v_sub_f32 v131, v131, v7
v_exp_f32 v116, v116
v_exp_f32 v117, v117
v_exp_f32 v118, v118
v_exp_f32 v119, v119
v_exp_f32 v120, v120
v_exp_f32 v121, v121
v_exp_f32 v122, v122
v_exp_f32 v123, v123
v_exp_f32 v124, v124
v_exp_f32 v125, v125
v_exp_f32 v126, v126
v_exp_f32 v127, v127
v_exp_f32 v128, v128
v_exp_f32 v129, v129
v_exp_f32 v130, v130
v_exp_f32 v131, v131
v_mul_f32 v196, v196, v1
v_mul_f32 v197, v197, v1
v_mul_f32 v198, v198, v1
v_mul_f32 v199, v199, v1
v_mul_f32 v200, v200, v1
v_mul_f32 v201, v201, v1
v_mul_f32 v202, v202, v1
v_mul_f32 v203, v203, v1
v_mul_f32 v204, v204, v1
v_mul_f32 v205, v205, v1
v_mul_f32 v206, v206, v1
v_mul_f32 v207, v207, v1
v_mul_f32 v208, v208, v1
v_mul_f32 v209, v209, v1
v_mul_f32 v210, v210, v1
v_mul_f32 v211, v211, v1
v_mul_f32 v80, v80, v1
v_mul_f32 v81, v81, v1
v_mul_f32 v82, v82, v1
v_mul_f32 v83, v83, v1
v_cvt_pk_bf16_f32 v64, v116, v117
v_cvt_pk_bf16_f32 v65, v118, v119
v_cvt_pk_bf16_f32 v66, v120, v121
v_cvt_pk_bf16_f32 v67, v122, v123
v_cvt_pk_bf16_f32 v68, v124, v125
v_cvt_pk_bf16_f32 v69, v126, v127
v_cvt_pk_bf16_f32 v70, v128, v129
v_cvt_pk_bf16_f32 v71, v130, v131
s_nop 1
v_mfma_f32_32x32x16_bf16 v[196:211], v[40:43], v[64:67], v[196:211]
v_mfma_f32_32x32x16_bf16 v[196:211], v[44:47], v[68:71], v[196:211]
v_smfmac_f32_16x16x64_bf16 v[80:83], v[72:75], v[64:71], v212
s_nop 11
ds_read_b128 v[32:35], v4 offset:6144
ds_read_b128 v[36:39], v4 offset:7168
ds_read_b128 v[48:51], v4 offset:14336
ds_read_b128 v[52:55], v4 offset:15360
s_waitcnt lgkmcnt(0)
v_mfma_f32_32x32x16_bf16 v[100:115], v[32:35], v[8:11], 0
v_mfma_f32_32x32x16_bf16 v[100:115], v[36:39], v[12:15], v[100:115]
s_nop 11
v_max3_f32 v7, v100, v101, v102
v_max3_f32 v7, v7, v103, v104
v_max3_f32 v7, v7, v105, v106
v_max3_f32 v7, v7, v107, v108
v_max3_f32 v7, v7, v109, v110
v_max3_f32 v7, v7, v111, v112
v_max3_f32 v7, v7, v113, v114
v_max3_f32 v7, v7, v115, v148
v_mov_b32 v1, v7
s_nop 1
v_permlane32_swap_b32 v7, v1
s_nop 0
v_max_f32 v7, v7, v1
v_sub_f32 v1, v148, v7
v_exp_f32 v1, v1
v_mov_b32 v148, v7
v_sub_f32 v100, v100, v7
v_sub_f32 v101, v101, v7
v_sub_f32 v102, v102, v7
v_sub_f32 v103, v103, v7
v_sub_f32 v104, v104, v7
v_sub_f32 v105, v105, v7
v_sub_f32 v106, v106, v7
v_sub_f32 v107, v107, v7
v_sub_f32 v108, v108, v7
v_sub_f32 v109, v109, v7
v_sub_f32 v110, v110, v7
v_sub_f32 v111, v111, v7
v_sub_f32 v112, v112, v7
v_sub_f32 v113, v113, v7
v_sub_f32 v114, v114, v7
v_sub_f32 v115, v115, v7
v_exp_f32 v100, v100
v_exp_f32 v101, v101
v_exp_f32 v102, v102
v_exp_f32 v103, v103
v_exp_f32 v104, v104
v_exp_f32 v105, v105
v_exp_f32 v106, v106
v_exp_f32 v107, v107
v_exp_f32 v108, v108
v_exp_f32 v109, v109
v_exp_f32 v110, v110
v_exp_f32 v111, v111
v_exp_f32 v112, v112
v_exp_f32 v113, v113
v_exp_f32 v114, v114
v_exp_f32 v115, v115
v_mul_f32 v180, v180, v1
v_mul_f32 v181, v181, v1
v_mul_f32 v182, v182, v1
v_mul_f32 v183, v183, v1
v_mul_f32 v184, v184, v1
v_mul_f32 v185, v185, v1
v_mul_f32 v186, v186, v1
v_mul_f32 v187, v187, v1
v_mul_f32 v188, v188, v1
v_mul_f32 v189, v189, v1
v_mul_f32 v190, v190, v1
v_mul_f32 v191, v191, v1
v_mul_f32 v192, v192, v1
v_mul_f32 v193, v193, v1
v_mul_f32 v194, v194, v1
v_mul_f32 v195, v195, v1
v_mul_f32 v76, v76, v1
v_mul_f32 v77, v77, v1
v_mul_f32 v78, v78, v1
v_mul_f32 v79, v79, v1
v_cvt_pk_bf16_f32 v56, v100, v101
v_cvt_pk_bf16_f32 v57, v102, v103
v_cvt_pk_bf16_f32 v58, v104, v105
v_cvt_pk_bf16_f32 v59, v106, v107
v_cvt_pk_bf16_f32 v60, v108, v109
v_cvt_pk_bf16_f32 v61, v110, v111
v_cvt_pk_bf16_f32 v62, v112, v113
v_cvt_pk_bf16_f32 v63, v114, v115
s_nop 1
v_mfma_f32_32x32x16_bf16 v[180:195], v[48:51], v[56:59], v[180:195]
v_mfma_f32_32x32x16_bf16 v[180:195], v[52:55], v[60:63], v[180:195]
v_smfmac_f32_16x16x64_bf16 v[76:79], v[72:75], v[56:63], v212
s_nop 11
v_mfma_f32_32x32x16_bf16 v[132:147], v[32:35], v[16:19], 0
v_mfma_f32_32x32x16_bf16 v[132:147], v[36:39], v[20:23], v[132:147]
s_nop 11
v_max3_f32 v7, v132, v133, v134
v_max3_f32 v7, v7, v135, v136
v_max3_f32 v7, v7, v137, v138
v_max3_f32 v7, v7, v139, v140
v_max3_f32 v7, v7, v141, v142
v_max3_f32 v7, v7, v143, v144
v_max3_f32 v7, v7, v145, v146
v_max3_f32 v7, v7, v147, v164
v_mov_b32 v1, v7
s_nop 1
v_permlane32_swap_b32 v7, v1
s_nop 0
v_max_f32 v7, v7, v1
v_sub_f32 v1, v164, v7
v_exp_f32 v1, v1
v_mov_b32 v164, v7
v_sub_f32 v132, v132, v7
v_sub_f32 v133, v133, v7
v_sub_f32 v134, v134, v7
v_sub_f32 v135, v135, v7
v_sub_f32 v136, v136, v7
v_sub_f32 v137, v137, v7
v_sub_f32 v138, v138, v7
v_sub_f32 v139, v139, v7
v_sub_f32 v140, v140, v7
v_sub_f32 v141, v141, v7
v_sub_f32 v142, v142, v7
v_sub_f32 v143, v143, v7
v_sub_f32 v144, v144, v7
v_sub_f32 v145, v145, v7
v_sub_f32 v146, v146, v7
v_sub_f32 v147, v147, v7
v_exp_f32 v132, v132
v_exp_f32 v133, v133
v_exp_f32 v134, v134
v_exp_f32 v135, v135
v_exp_f32 v136, v136
v_exp_f32 v137, v137
v_exp_f32 v138, v138
v_exp_f32 v139, v139
v_exp_f32 v140, v140
v_exp_f32 v141, v141
v_exp_f32 v142, v142
v_exp_f32 v143, v143
v_exp_f32 v144, v144
v_exp_f32 v145, v145
v_exp_f32 v146, v146
v_exp_f32 v147, v147
v_mul_f32 v196, v196, v1
v_mul_f32 v197, v197, v1
v_mul_f32 v198, v198, v1
v_mul_f32 v199, v199, v1
v_mul_f32 v200, v200, v1
v_mul_f32 v201, v201, v1
v_mul_f32 v202, v202, v1
v_mul_f32 v203, v203, v1
v_mul_f32 v204, v204, v1
v_mul_f32 v205, v205, v1
v_mul_f32 v206, v206, v1
v_mul_f32 v207, v207, v1
v_mul_f32 v208, v208, v1
v_mul_f32 v209, v209, v1
v_mul_f32 v210, v210, v1
v_mul_f32 v211, v211, v1
v_mul_f32 v80, v80, v1
v_mul_f32 v81, v81, v1
v_mul_f32 v82, v82, v1
v_mul_f32 v83, v83, v1
v_cvt_pk_bf16_f32 v64, v132, v133
v_cvt_pk_bf16_f32 v65, v134, v135
v_cvt_pk_bf16_f32 v66, v136, v137
v_cvt_pk_bf16_f32 v67, v138, v139
v_cvt_pk_bf16_f32 v68, v140, v141
v_cvt_pk_bf16_f32 v69, v142, v143
v_cvt_pk_bf16_f32 v70, v144, v145
v_cvt_pk_bf16_f32 v71, v146, v147
s_nop 1
v_mfma_f32_32x32x16_bf16 v[196:211], v[48:51], v[64:67], v[196:211]
v_mfma_f32_32x32x16_bf16 v[196:211], v[52:55], v[68:71], v[196:211]
v_smfmac_f32_16x16x64_bf16 v[80:83], v[72:75], v[64:71], v212
s_nop 11
s_barrier
s_sub_u32 s28, s28, 1
s_cmp_lg_u32 s28, 0
s_cbranch_scc1 ATT_SLOW
v_add_f32 v76, v76, v77
v_add_f32 v80, v80, v81
ATT_FIN:
v_rcp_f32 v6, v76
s_nop 0
v_mul_f32 v180, v180, v6
v_mul_f32 v181, v181, v6
v_mul_f32 v182, v182, v6
v_mul_f32 v183, v183, v6
v_mul_f32 v184, v184, v6
v_mul_f32 v185, v185, v6
v_mul_f32 v186, v186, v6
v_mul_f32 v187, v187, v6
v_mul_f32 v188, v188, v6
v_mul_f32 v189, v189, v6
v_mul_f32 v190, v190, v6
v_mul_f32 v191, v191, v6
v_mul_f32 v192, v192, v6
v_mul_f32 v193, v193, v6
v_mul_f32 v194, v194, v6
v_mul_f32 v195, v195, v6
v_cvt_pk_bf16_f32 v56, v180, v181
v_cvt_pk_bf16_f32 v57, v182, v183
v_cvt_pk_bf16_f32 v58, v184, v185
v_cvt_pk_bf16_f32 v59, v186, v187
v_cvt_pk_bf16_f32 v60, v188, v189
v_cvt_pk_bf16_f32 v61, v190, v191
v_cvt_pk_bf16_f32 v62, v192, v193
v_cvt_pk_bf16_f32 v63, v194, v195
s_add_u32 s30, s9, 0
s_lshl_b32 s30, s30, 6
s_lshl_b32 s31, s89, 1
s_add_u32 s30, s30, s31
s_lshl_b32 s30, s30, 10
s_add_u32 s30, s30, 12582912
buffer_store_dwordx4 v[56:59], v3, s[24:27], s30 offen sc1
buffer_store_dwordx4 v[60:63], v3, s[24:27], s30 offen offset:1024 sc1
v_rcp_f32 v6, v80
s_nop 0
v_mul_f32 v196, v196, v6
v_mul_f32 v197, v197, v6
v_mul_f32 v198, v198, v6
v_mul_f32 v199, v199, v6
v_mul_f32 v200, v200, v6
v_mul_f32 v201, v201, v6
v_mul_f32 v202, v202, v6
v_mul_f32 v203, v203, v6
v_mul_f32 v204, v204, v6
v_mul_f32 v205, v205, v6
v_mul_f32 v206, v206, v6
v_mul_f32 v207, v207, v6
v_mul_f32 v208, v208, v6
v_mul_f32 v209, v209, v6
v_mul_f32 v210, v210, v6
v_mul_f32 v211, v211, v6
v_cvt_pk_bf16_f32 v64, v196, v197
v_cvt_pk_bf16_f32 v65, v198, v199
v_cvt_pk_bf16_f32 v66, v200, v201
v_cvt_pk_bf16_f32 v67, v202, v203
v_cvt_pk_bf16_f32 v68, v204, v205
v_cvt_pk_bf16_f32 v69, v206, v207
v_cvt_pk_bf16_f32 v70, v208, v209
v_cvt_pk_bf16_f32 v71, v210, v211
s_add_u32 s30, s9, 1
s_lshl_b32 s30, s30, 6
s_lshl_b32 s31, s89, 1
s_add_u32 s30, s30, s31
s_lshl_b32 s30, s30, 10
s_add_u32 s30, s30, 12582912
buffer_store_dwordx4 v[64:67], v3, s[24:27], s30 offen sc1
buffer_store_dwordx4 v[68:71], v3, s[24:27], s30 offen offset:1024 sc1
s_waitcnt vmcnt(0)
s_barrier
s_mov_b32 s4, s68
s_mov_b32 s5, s69
s_mov_b32 s6, s84
s_mov_b32 s7, s85
s_mov_b32 s8, s64
s_mov_b32 s9, s65
s_and_b32 s40, s2, 7
s_lshr_b32 s41, s2, 3
s_and_b32 s12, s40, 3
s_lshl_b32 s12, s12, 2
s_and_b32 s42, s41, 3
s_add_u32 s12, s12, s42
s_lshr_b32 s13, s40, 2
s_lshl_b32 s13, s13, 3
s_lshr_b32 s42, s41, 2
s_add_u32 s13, s13, s42
s_waitcnt lgkmcnt(0)
s_mov_b32 s32, s3
s_mov_b32 s33, 0
s_lshl_b32 s34, s32, 12
v_and_b32 v6, 15, v2
v_lshlrev_b32 v6, 4, v6
v_bfe_u32 v1, v2, 4, 1
v_lshl_add_u32 v6, v1, 9, v6
v_bfe_u32 v1, v2, 5, 1
v_lshl_add_u32 v6, v1, 10, v6
v_add_u32 v6, s34, v6
v_bfe_u32 v1, v2, 2, 2
v_lshlrev_b32 v7, 6, v1
v_and_b32 v1, 3, v2
v_lshl_add_u32 v7, v1, 3, v7
v_bfe_u32 v1, v2, 5, 1
v_lshl_add_u32 v7, v1, 11, v7
v_bfe_u32 v1, v2, 4, 1
v_lshl_add_u32 v7, v1, 9, v7
v_lshl_add_u32 v7, v1, 5, v7
v_xor_b32 v8, 32, v7
v_mov_b32 v3, v6
v_mov_b32 v4, v7
v_mov_b32 v5, v8
s_mov_b32 s24, s8
s_mov_b32 s25, s9
s_mov_b32 s26, 4194304
s_mov_b32 s27, 0x20000
v_and_b32 v112, 31, v2
v_lshlrev_b32 v112, 11, v112
v_bfe_u32 v1, v2, 5, 1
v_lshl_add_u32 v112, v1, 4, v112
s_lshl_b32 s36, s12, 2
s_add_u32 s36, s36, s32
s_lshl_b32 s37, s36, 16
s_lshl_b32 s38, s13, 7
s_add_u32 s37, s37, s38
buffer_load_dwordx4 v[96:99], v112, s[24:27], s37 offen offset:0
buffer_load_dwordx4 v[100:103], v112, s[24:27], s37 offen offset:32
buffer_load_dwordx4 v[104:107], v112, s[24:27], s37 offen offset:64
buffer_load_dwordx4 v[108:111], v112, s[24:27], s37 offen offset:96
s_mov_b32 s39, 0xffff0000
s_waitcnt vmcnt(0)
v_permlane16_swap_b32 v96, v98
v_permlane16_swap_b32 v97, v99
v_permlane16_swap_b32 v100, v102
v_permlane16_swap_b32 v101, v103
v_permlane16_swap_b32 v104, v106
v_permlane16_swap_b32 v105, v107
v_permlane16_swap_b32 v108, v110
v_permlane16_swap_b32 v109, v111
s_nop 0
v_lshlrev_b32 v60, 16, v96
v_and_b32 v61, s39, v96
v_lshlrev_b32 v62, 16, v97
v_and_b32 v63, s39, v97
v_lshlrev_b32 v64, 16, v98
v_and_b32 v65, s39, v98
v_lshlrev_b32 v66, 16, v99
v_and_b32 v67, s39, v99
v_lshlrev_b32 v68, 16, v100
v_and_b32 v69, s39, v100
v_lshlrev_b32 v70, 16, v101
v_and_b32 v71, s39, v101
v_lshlrev_b32 v72, 16, v102
v_and_b32 v73, s39, v102
v_lshlrev_b32 v74, 16, v103
v_and_b32 v75, s39, v103
v_lshlrev_b32 v76, 16, v104
v_and_b32 v77, s39, v104
v_lshlrev_b32 v78, 16, v105
v_and_b32 v79, s39, v105
v_lshlrev_b32 v80, 16, v106
v_and_b32 v81, s39, v106
v_lshlrev_b32 v82, 16, v107
v_and_b32 v83, s39, v107
v_lshlrev_b32 v84, 16, v108
v_and_b32 v85, s39, v108
v_lshlrev_b32 v86, 16, v109
v_and_b32 v87, s39, v109
v_lshlrev_b32 v88, 16, v110
v_and_b32 v89, s39, v110
v_lshlrev_b32 v90, 16, v111
v_and_b32 v91, s39, v111
s_mov_b32 s14, 0
s_barrier
s_barrier
s_setprio 1
ds_read_b128 v[12:15], v3 offset:0
ds_read_b64_tr_b16 v[28:29], v4 offset:16384
ds_read_b64_tr_b16 v[30:31], v4 offset:17408
ds_read_b128 v[16:19], v3 offset:256
ds_read_b64_tr_b16 v[32:33], v5 offset:16384
ds_read_b64_tr_b16 v[34:35], v5 offset:17408
ds_read_b64_tr_b16 v[36:37], v4 offset:16640
ds_read_b64_tr_b16 v[38:39], v4 offset:17664
ds_read_b64_tr_b16 v[40:41], v5 offset:16640
ds_read_b64_tr_b16 v[42:43], v5 offset:17664
s_mov_b32 s15, 16
.p2align 4
WO_CLOOP:
s_waitcnt lgkmcnt(6)
v_mfma_f32_16x16x32_bf16 v[60:63], v[28:31], v[12:15], v[60:63]
ds_read_b128 v[20:23], v3 offset:2048
ds_read_b64_tr_b16 v[44:45], v4 offset:20480
v_mfma_f32_16x16x32_bf16 v[64:67], v[28:31], v[16:19], v[64:67]
ds_read_b64_tr_b16 v[46:47], v4 offset:21504
ds_read_b128 v[24:27], v3 offset:2304
s_waitcnt lgkmcnt(8)
v_mfma_f32_16x16x32_bf16 v[68:71], v[32:35], v[12:15], v[68:71]
ds_read_b64_tr_b16 v[48:49], v5 offset:20480
v_mfma_f32_16x16x32_bf16 v[72:75], v[32:35], v[16:19], v[72:75]
ds_read_b64_tr_b16 v[50:51], v5 offset:21504
ds_read_b64_tr_b16 v[52:53], v4 offset:20736
s_waitcnt lgkmcnt(9)
v_mfma_f32_16x16x32_bf16 v[76:79], v[36:39], v[12:15], v[76:79]
ds_read_b64_tr_b16 v[54:55], v4 offset:21760
ds_read_b64_tr_b16 v[56:57], v5 offset:20736
v_mfma_f32_16x16x32_bf16 v[80:83], v[36:39], v[16:19], v[80:83]
ds_read_b64_tr_b16 v[58:59], v5 offset:21760
s_add_u32 s14, s14, 24576
s_cmp_eq_u32 s14, 122880
s_waitcnt lgkmcnt(10)
v_mfma_f32_16x16x32_bf16 v[84:87], v[40:43], v[12:15], v[84:87]
s_cselect_b32 s14, 0, s14
v_add_u32 v3, s14, v6
v_mfma_f32_16x16x32_bf16 v[88:91], v[40:43], v[16:19], v[88:91]
v_add_u32 v4, s14, v7
v_add_u32 v5, s14, v8
s_waitcnt lgkmcnt(6)
v_mfma_f32_16x16x32_bf16 v[60:63], v[44:47], v[20:23], v[60:63]
v_mfma_f32_16x16x32_bf16 v[64:67], v[44:47], v[24:27], v[64:67]
s_waitcnt lgkmcnt(0)
s_barrier
ds_read_b128 v[12:15], v3 offset:0
ds_read_b64_tr_b16 v[28:29], v4 offset:16384
v_mfma_f32_16x16x32_bf16 v[68:71], v[48:51], v[20:23], v[68:71]
ds_read_b64_tr_b16 v[30:31], v4 offset:17408
ds_read_b128 v[16:19], v3 offset:256
v_mfma_f32_16x16x32_bf16 v[72:75], v[48:51], v[24:27], v[72:75]
ds_read_b64_tr_b16 v[32:33], v5 offset:16384
v_mfma_f32_16x16x32_bf16 v[76:79], v[52:55], v[20:23], v[76:79]
ds_read_b64_tr_b16 v[34:35], v5 offset:17408
ds_read_b64_tr_b16 v[36:37], v4 offset:16640
v_mfma_f32_16x16x32_bf16 v[80:83], v[52:55], v[24:27], v[80:83]
ds_read_b64_tr_b16 v[38:39], v4 offset:17664
ds_read_b64_tr_b16 v[40:41], v5 offset:16640
v_mfma_f32_16x16x32_bf16 v[84:87], v[56:59], v[20:23], v[84:87]
ds_read_b64_tr_b16 v[42:43], v5 offset:17664
s_sub_u32 s15, s15, 1
s_cmp_lg_u32 s15, 0
v_mfma_f32_16x16x32_bf16 v[88:91], v[56:59], v[24:27], v[88:91]
s_cbranch_scc1 WO_CLOOP
s_waitcnt lgkmcnt(0)
s_setprio 0
s_nop 7
s_mov_b32 s16, s6
s_mov_b32 s17, s7
s_mov_b32 s18, 44040192
s_mov_b32 s19, 0x20000
v_and_b32 v112, 15, v2
v_lshlrev_b32 v112, 4, v112
v_bfe_u32 v1, v2, 4, 1
v_lshl_add_u32 v112, v1, 9, v112
v_bfe_u32 v1, v2, 5, 1
v_lshl_add_u32 v112, v1, 8, v112
s_lshl_b32 s37, s36, 6
s_lshl_b32 s38, s13, 2
s_add_u32 s37, s37, s38
s_lshl_b32 s37, s37, 10
s_add_u32 s37, s37, 16777216
v_cvt_pk_bf16_f32 v96, v60, v61
v_cvt_pk_bf16_f32 v97, v62, v63
v_cvt_pk_bf16_f32 v98, v64, v65
v_cvt_pk_bf16_f32 v99, v66, v67
s_nop 1
v_permlane32_swap_b32 v96, v98
v_permlane32_swap_b32 v97, v99
buffer_store_dwordx4 v[96:99], v112, s[16:19], s37 offen offset:0 sc1
v_cvt_pk_bf16_f32 v100, v68, v69
v_cvt_pk_bf16_f32 v101, v70, v71
v_cvt_pk_bf16_f32 v102, v72, v73
v_cvt_pk_bf16_f32 v103, v74, v75
s_nop 1
v_permlane32_swap_b32 v100, v102
v_permlane32_swap_b32 v101, v103
buffer_store_dwordx4 v[100:103], v112, s[16:19], s37 offen offset:1024 sc1
v_cvt_pk_bf16_f32 v104, v76, v77
v_cvt_pk_bf16_f32 v105, v78, v79
v_cvt_pk_bf16_f32 v106, v80, v81
v_cvt_pk_bf16_f32 v107, v82, v83
s_nop 1
v_permlane32_swap_b32 v104, v106
v_permlane32_swap_b32 v105, v107
buffer_store_dwordx4 v[104:107], v112, s[16:19], s37 offen offset:2048 sc1
v_cvt_pk_bf16_f32 v108, v84, v85
v_cvt_pk_bf16_f32 v109, v86, v87
v_cvt_pk_bf16_f32 v110, v88, v89
v_cvt_pk_bf16_f32 v111, v90, v91
s_nop 1
v_permlane32_swap_b32 v108, v110
v_permlane32_swap_b32 v109, v111
buffer_store_dwordx4 v[108:111], v112, s[16:19], s37 offen offset:3072 sc1
v_mov_b32 v114, 0
v_mov_b32 v115, 0
v_mov_b32 v116, 0
v_mov_b32 v117, 0
v_pk_add_f32 v[114:115], v[60:61], v[114:115]
v_pk_fma_f32 v[116:117], v[60:61], v[60:61], v[116:117]
v_pk_add_f32 v[114:115], v[62:63], v[114:115]
v_pk_fma_f32 v[116:117], v[62:63], v[62:63], v[116:117]
v_pk_add_f32 v[114:115], v[68:69], v[114:115]
v_pk_fma_f32 v[116:117], v[68:69], v[68:69], v[116:117]
v_pk_add_f32 v[114:115], v[70:71], v[114:115]
v_pk_fma_f32 v[116:117], v[70:71], v[70:71], v[116:117]
v_pk_add_f32 v[114:115], v[76:77], v[114:115]
v_pk_fma_f32 v[116:117], v[76:77], v[76:77], v[116:117]
v_pk_add_f32 v[114:115], v[78:79], v[114:115]
v_pk_fma_f32 v[116:117], v[78:79], v[78:79], v[116:117]
v_pk_add_f32 v[114:115], v[84:85], v[114:115]
v_pk_fma_f32 v[116:117], v[84:85], v[84:85], v[116:117]
v_pk_add_f32 v[114:115], v[86:87], v[114:115]
v_pk_fma_f32 v[116:117], v[86:87], v[86:87], v[116:117]
v_add_f32 v114, v114, v115
v_add_f32 v115, v116, v117
v_mov_b32 v118, 0
v_mov_b32 v119, 0
v_mov_b32 v120, 0
v_mov_b32 v121, 0
v_pk_add_f32 v[118:119], v[64:65], v[118:119]
v_pk_fma_f32 v[120:121], v[64:65], v[64:65], v[120:121]
v_pk_add_f32 v[118:119], v[66:67], v[118:119]
v_pk_fma_f32 v[120:121], v[66:67], v[66:67], v[120:121]
v_pk_add_f32 v[118:119], v[72:73], v[118:119]
v_pk_fma_f32 v[120:121], v[72:73], v[72:73], v[120:121]
v_pk_add_f32 v[118:119], v[74:75], v[118:119]
v_pk_fma_f32 v[120:121], v[74:75], v[74:75], v[120:121]
v_pk_add_f32 v[118:119], v[80:81], v[118:119]
v_pk_fma_f32 v[120:121], v[80:81], v[80:81], v[120:121]
v_pk_add_f32 v[118:119], v[82:83], v[118:119]
v_pk_fma_f32 v[120:121], v[82:83], v[82:83], v[120:121]
v_pk_add_f32 v[118:119], v[88:89], v[118:119]
v_pk_fma_f32 v[120:121], v[88:89], v[88:89], v[120:121]
v_pk_add_f32 v[118:119], v[90:91], v[118:119]
v_pk_fma_f32 v[120:121], v[90:91], v[90:91], v[120:121]
v_add_f32 v118, v118, v119
v_add_f32 v119, v120, v121
v_mov_b32 v122, v114
v_mov_b32 v123, v115
v_mov_b32 v126, v118
v_mov_b32 v127, v119
s_nop 1
v_permlane16_swap_b32 v114, v122
v_permlane16_swap_b32 v115, v123
v_permlane16_swap_b32 v118, v126
v_permlane16_swap_b32 v119, v127
s_nop 0
v_add_f32 v114, v114, v122
v_add_f32 v115, v115, v123
v_add_f32 v118, v118, v126
v_add_f32 v119, v119, v127
v_mov_b32 v122, v114
v_mov_b32 v123, v115
v_mov_b32 v126, v118
v_mov_b32 v127, v119
s_nop 1
v_permlane32_swap_b32 v114, v122
v_permlane32_swap_b32 v115, v123
v_permlane32_swap_b32 v118, v126
v_permlane32_swap_b32 v119, v127
s_nop 0
v_add_f32 v114, v114, v122
v_add_f32 v115, v115, v123
v_add_f32 v118, v118, v126
v_add_f32 v119, v119, v127
v_and_b32 v113, 15, v2
v_lshlrev_b32 v113, 3, v113
s_lshl_b32 s37, s13, 14
s_lshl_b32 s38, s36, 8
s_add_u32 s37, s37, s38
s_add_u32 s37, s37, 42991616
s_mov_b64 exec, 0xffff
buffer_store_dwordx2 v[114:115], v113, s[16:19], s37 offen sc1
buffer_store_dwordx2 v[118:119], v113, s[16:19], s37 offen offset:128 sc1
s_mov_b64 exec, -1
s_waitcnt vmcnt(0)
s_barrier
s_mov_b32 s4, s72
s_mov_b32 s5, s73
s_mov_b32 s6, s84
s_mov_b32 s7, s85
s_mov_b32 s8, s74
s_mov_b32 s9, s75
s_and_b32 s40, s2, 7
s_lshr_b32 s41, s2, 3
s_and_b32 s12, s40, 1
s_lshl_b32 s12, s12, 3
s_and_b32 s42, s41, 7
s_add_u32 s12, s12, s42
s_lshr_b32 s13, s40, 1
s_lshl_b32 s13, s13, 2
s_lshr_b32 s42, s41, 3
s_add_u32 s13, s13, s42
s_waitcnt lgkmcnt(0)
s_lshr_b32 s32, s3, 1
s_and_b32 s33, s3, 1
v_bfe_u32 v9, v2, 5, 1
v_bfe_u32 v10, v2, 4, 1
v_and_b32 v11, 15, v2
v_lshlrev_b32 v6, 4, v11
v_lshl_add_u32 v6, v10, 9, v6
v_lshl_add_u32 v6, v9, 10, v6
s_lshl_b32 s34, s32, 13
v_add_u32 v6, s34, v6
v_bfe_u32 v1, v2, 2, 2
v_lshlrev_b32 v7, 6, v1
v_and_b32 v1, 3, v2
v_lshl_add_u32 v7, v1, 3, v7
v_lshl_add_u32 v7, v10, 11, v7
v_lshl_add_u32 v7, v9, 13, v7
s_and_b32 s35, s13, 1
v_xor_b32 v1, s33, v10
v_lshl_add_u32 v8, v1, 5, v7
v_xor_b32 v1, 1, v1
v_lshl_add_u32 v7, v1, 5, v7
s_mul_i32 s34, s33, 3
s_add_u32 s34, s34, s35
s_lshl_b32 s34, s34, 8
v_add_u32 v1, s34, v8
s_lshl_b32 s34, s33, 2
s_add_u32 s34, s34, s35
s_lshl_b32 s34, s34, 8
v_add_u32 v8, s34, v7
v_mov_b32 v7, v1
v_mov_b32 v3, v6
v_mov_b32 v4, v7
v_mov_b32 v5, v8
v_mov_b32 v100, 0
v_mov_b32 v101, 0
v_mov_b32 v102, 0
v_mov_b32 v103, 0
v_mov_b32 v104, 0
v_mov_b32 v105, 0
v_mov_b32 v106, 0
v_mov_b32 v107, 0
v_mov_b32 v108, 0
v_mov_b32 v109, 0
v_mov_b32 v110, 0
v_mov_b32 v111, 0
v_mov_b32 v112, 0
v_mov_b32 v113, 0
v_mov_b32 v114, 0
v_mov_b32 v115, 0
v_mov_b32 v116, 0
v_mov_b32 v117, 0
v_mov_b32 v118, 0
v_mov_b32 v119, 0
v_mov_b32 v120, 0
v_mov_b32 v121, 0
v_mov_b32 v122, 0
v_mov_b32 v123, 0
v_mov_b32 v124, 0
v_mov_b32 v125, 0
v_mov_b32 v126, 0
v_mov_b32 v127, 0
v_mov_b32 v128, 0
v_mov_b32 v129, 0
v_mov_b32 v130, 0
v_mov_b32 v131, 0
v_mov_b32 v132, 0
v_mov_b32 v133, 0
v_mov_b32 v134, 0
v_mov_b32 v135, 0
v_mov_b32 v136, 0
v_mov_b32 v137, 0
v_mov_b32 v138, 0
v_mov_b32 v139, 0
v_mov_b32 v140, 0
v_mov_b32 v141, 0
v_mov_b32 v142, 0
v_mov_b32 v143, 0
v_mov_b32 v144, 0
v_mov_b32 v145, 0
v_mov_b32 v146, 0
v_mov_b32 v147, 0
v_mov_b32 v148, 0
v_mov_b32 v149, 0
v_mov_b32 v150, 0
v_mov_b32 v151, 0
v_mov_b32 v152, 0
v_mov_b32 v153, 0
v_mov_b32 v154, 0
v_mov_b32 v155, 0
v_mov_b32 v156, 0
v_mov_b32 v157, 0
v_mov_b32 v158, 0
v_mov_b32 v159, 0
v_mov_b32 v160, 0
v_mov_b32 v161, 0
v_mov_b32 v162, 0
v_mov_b32 v163, 0
v_mov_b32 v164, 0
v_mov_b32 v165, 0
v_mov_b32 v166, 0
v_mov_b32 v167, 0
v_mov_b32 v168, 0
v_mov_b32 v169, 0
v_mov_b32 v170, 0
v_mov_b32 v171, 0
v_mov_b32 v172, 0
v_mov_b32 v173, 0
v_mov_b32 v174, 0
v_mov_b32 v175, 0
v_mov_b32 v176, 0
v_mov_b32 v177, 0
v_mov_b32 v178, 0
v_mov_b32 v179, 0
v_mov_b32 v180, 0
v_mov_b32 v181, 0
v_mov_b32 v182, 0
v_mov_b32 v183, 0
v_mov_b32 v184, 0
v_mov_b32 v185, 0
v_mov_b32 v186, 0
v_mov_b32 v187, 0
v_mov_b32 v188, 0
v_mov_b32 v189, 0
v_mov_b32 v190, 0
v_mov_b32 v191, 0
v_mov_b32 v192, 0
v_mov_b32 v193, 0
v_mov_b32 v194, 0
v_mov_b32 v195, 0
v_mov_b32 v196, 0
v_mov_b32 v197, 0
v_mov_b32 v198, 0
v_mov_b32 v199, 0
v_mov_b32 v200, 0
v_mov_b32 v201, 0
v_mov_b32 v202, 0
v_mov_b32 v203, 0
v_mov_b32 v204, 0
v_mov_b32 v205, 0
v_mov_b32 v206, 0
v_mov_b32 v207, 0
v_mov_b32 v208, 0
v_mov_b32 v209, 0
v_mov_b32 v210, 0
v_mov_b32 v211, 0
s_mov_b32 s28, s8
s_mov_b32 s29, s9
s_mov_b32 s30, 7168
s_mov_b32 s31, 0x20000
s_mul_i32 s38, s13, 224
s_mul_i32 s39, s3, 56
s_add_u32 s38, s38, s39
v_min_u32 v226, 55, v2
v_lshlrev_b32 v225, 2, v226
v_lshlrev_b32 v227, 1, v226
s_lshl_b32 s39, s38, 1
buffer_load_ushort v228, v227, s[28:31], s39 offen
s_waitcnt vmcnt(0)
v_lshlrev_b32 v228, 16, v228
s_mul_i32 s39, s3, 224
s_add_u32 s39, s39, 147456
v_add_u32 v225, s39, v225
ds_write_b32 v225, v228 offset:1024
s_waitcnt lgkmcnt(0)
s_mov_b32 s14, 0
s_barrier
v_mov_b32 v12, 0x3f803f80
v_mov_b32 v13, 0x3f803f80
v_mov_b32 v14, 0x3f803f80
v_mov_b32 v15, 0x3f803f80
s_mov_b32 s24, s6
s_mov_b32 s25, s7
s_mov_b32 s26, 48234496
s_mov_b32 s27, 0x20000
s_lshl_b32 s37, s32, 9
s_add_u32 s37, s37, 98304
v_add_u32 v9, s37, v7
v_add_u32 v10, s37, v8
ds_read_b64_tr_b16 v[44:45], v9 offset:16384
ds_read_b64_tr_b16 v[46:47], v9 offset:20480
ds_read_b64_tr_b16 v[48:49], v9 offset:32768
ds_read_b64_tr_b16 v[50:51], v9 offset:36864
ds_read_b64_tr_b16 v[52:53], v10 offset:16384
ds_read_b64_tr_b16 v[54:55], v10 offset:20480
ds_read_b64_tr_b16 v[56:57], v10 offset:32768
ds_read_b64_tr_b16 v[58:59], v10 offset:36864
ds_read_b64_tr_b16 v[60:61], v9 offset:16640
ds_read_b64_tr_b16 v[62:63], v9 offset:20736
ds_read_b64_tr_b16 v[64:65], v9 offset:33024
ds_read_b64_tr_b16 v[66:67], v9 offset:37120
ds_read_b64_tr_b16 v[68:69], v10 offset:16640
ds_read_b64_tr_b16 v[70:71], v10 offset:20736
ds_read_b64_tr_b16 v[72:73], v10 offset:33024
ds_read_b64_tr_b16 v[74:75], v10 offset:37120
s_waitcnt lgkmcnt(0)
v_mfma_f32_16x16x32_bf16 v[212:215], v[44:47], v[12:15], 0
v_mfma_f32_16x16x32_bf16 v[216:219], v[52:55], v[12:15], 0
v_mfma_f32_16x16x32_bf16 v[220:223], v[60:63], v[12:15], 0
v_mfma_f32_16x16x32_bf16 v[224:227], v[68:71], v[12:15], 0
v_mfma_f32_16x16x32_bf16 v[212:215], v[48:51], v[12:15], v[212:215]
v_mfma_f32_16x16x32_bf16 v[216:219], v[56:59], v[12:15], v[216:219]
v_mfma_f32_16x16x32_bf16 v[220:223], v[64:67], v[12:15], v[220:223]
v_mfma_f32_16x16x32_bf16 v[224:227], v[72:75], v[12:15], v[224:227]
s_mul_i32 s36, s13, 14336
s_mul_i32 s37, s12, 896
s_add_u32 s36, s36, s37
s_add_u32 s36, s36, 46137344
s_mul_i32 s37, s33, 448
s_add_u32 s36, s36, s37
s_lshl_b32 s37, s32, 8
s_add_u32 s36, s36, s37
v_lshrrev_b32 v11, 4, v2
v_lshlrev_b32 v11, 4, v11
s_nop 3
s_mov_b32 exec_lo, 0x00010001
s_mov_b32 exec_hi, 0x00010001
buffer_store_dwordx4 v[212:215], v11, s[24:27], s36 offen offset:0 sc1
buffer_store_dwordx4 v[216:219], v11, s[24:27], s36 offen offset:64 sc1
buffer_store_dwordx4 v[220:223], v11, s[24:27], s36 offen offset:128 sc1
s_cmp_lg_u32 s32, 0
s_cbranch_scc1 FFN1_NOS3
buffer_store_dwordx4 v[224:227], v11, s[24:27], s36 offen offset:192 sc1
FFN1_NOS3:
s_mov_b64 exec, -1
s_barrier
s_setprio 1
ds_read_b128 v[12:15], v3 offset:0
ds_read_b64_tr_b16 v[44:45], v4 offset:16384
ds_read_b64_tr_b16 v[46:47], v4 offset:20480
ds_read_b128 v[16:19], v3 offset:256
ds_read_b128 v[20:23], v3 offset:4096
ds_read_b128 v[24:27], v3 offset:4352
ds_read_b64_tr_b16 v[48:49], v5 offset:16384
ds_read_b64_tr_b16 v[50:51], v5 offset:20480
ds_read_b64_tr_b16 v[52:53], v4 offset:16640
ds_read_b64_tr_b16 v[54:55], v4 offset:20736
ds_read_b64_tr_b16 v[56:57], v5 offset:16640
ds_read_b64_tr_b16 v[58:59], v5 offset:20736
ds_read_b64_tr_b16 v[60:61], v4 offset:16896
ds_read_b64_tr_b16 v[62:63], v4 offset:20992
ds_read_b64_tr_b16 v[64:65], v5 offset:16896
ds_read_b64_tr_b16 v[66:67], v5 offset:20992
ds_read_b64_tr_b16 v[68:69], v4 offset:17152
ds_read_b64_tr_b16 v[70:71], v4 offset:21248
s_mov_b32 s15, 16
.p2align 4
FFN1_CLOOP:
s_waitcnt lgkmcnt(12)
v_mfma_f32_16x16x32_bf16 v[100:103], v[44:47], v[12:15], v[100:103]
s_cmp_eq_u32 s15, 14
s_cbranch_scc1 FFN1_DOVM
FFN1_NOVM:
ds_read_b128 v[28:31], v3 offset:2048
v_mfma_f32_16x16x32_bf16 v[104:107], v[44:47], v[16:19], v[104:107]
ds_read_b64_tr_b16 v[72:73], v4 offset:32768
v_mfma_f32_16x16x32_bf16 v[108:111], v[44:47], v[20:23], v[108:111]
ds_read_b64_tr_b16 v[74:75], v4 offset:36864
v_mfma_f32_16x16x32_bf16 v[112:115], v[44:47], v[24:27], v[112:115]
ds_read_b128 v[32:35], v3 offset:2304
s_waitcnt lgkmcnt(14)
v_mfma_f32_16x16x32_bf16 v[116:119], v[48:51], v[12:15], v[116:119]
ds_read_b128 v[36:39], v3 offset:6144
v_mfma_f32_16x16x32_bf16 v[120:123], v[48:51], v[16:19], v[120:123]
ds_read_b128 v[40:43], v3 offset:6400
v_mfma_f32_16x16x32_bf16 v[124:127], v[48:51], v[20:23], v[124:127]
ds_read_b64_tr_b16 v[76:77], v5 offset:32768
v_mfma_f32_16x16x32_bf16 v[128:131], v[48:51], v[24:27], v[128:131]
ds_read_b64_tr_b16 v[78:79], v5 offset:36864
s_waitcnt lgkmcnt(15)
v_mfma_f32_16x16x32_bf16 v[132:135], v[52:55], v[12:15], v[132:135]
ds_read_b64_tr_b16 v[80:81], v4 offset:33024
v_mfma_f32_16x16x32_bf16 v[136:139], v[52:55], v[16:19], v[136:139]
v_mfma_f32_16x16x32_bf16 v[140:143], v[52:55], v[20:23], v[140:143]
ds_read_b64_tr_b16 v[82:83], v4 offset:37120
v_mfma_f32_16x16x32_bf16 v[144:147], v[52:55], v[24:27], v[144:147]
ds_read_b64_tr_b16 v[84:85], v5 offset:33024
s_waitcnt lgkmcnt(15)
v_mfma_f32_16x16x32_bf16 v[148:151], v[56:59], v[12:15], v[148:151]
ds_read_b64_tr_b16 v[86:87], v5 offset:37120
v_mfma_f32_16x16x32_bf16 v[152:155], v[56:59], v[16:19], v[152:155]
ds_read_b64_tr_b16 v[88:89], v4 offset:33280
v_mfma_f32_16x16x32_bf16 v[156:159], v[56:59], v[20:23], v[156:159]
ds_read_b64_tr_b16 v[90:91], v4 offset:37376
v_mfma_f32_16x16x32_bf16 v[160:163], v[56:59], v[24:27], v[160:163]
ds_read_b64_tr_b16 v[92:93], v5 offset:33280
s_waitcnt lgkmcnt(15)
v_mfma_f32_16x16x32_bf16 v[164:167], v[60:63], v[12:15], v[164:167]
ds_read_b64_tr_b16 v[94:95], v5 offset:37376
v_mfma_f32_16x16x32_bf16 v[168:171], v[60:63], v[16:19], v[168:171]
ds_read_b64_tr_b16 v[96:97], v4 offset:33536
v_mfma_f32_16x16x32_bf16 v[172:175], v[60:63], v[20:23], v[172:175]
ds_read_b64_tr_b16 v[98:99], v4 offset:37632
s_add_u32 s14, s14, 49152
v_mfma_f32_16x16x32_bf16 v[176:179], v[60:63], v[24:27], v[176:179]
s_cmp_eq_u32 s14, 147456
s_waitcnt lgkmcnt(15)
v_mfma_f32_16x16x32_bf16 v[180:183], v[64:67], v[12:15], v[180:183]
s_cselect_b32 s14, 0, s14
v_mfma_f32_16x16x32_bf16 v[184:187], v[64:67], v[16:19], v[184:187]
v_add_u32 v3, s14, v6
v_mfma_f32_16x16x32_bf16 v[188:191], v[64:67], v[20:23], v[188:191]
v_add_u32 v4, s14, v7
v_mfma_f32_16x16x32_bf16 v[192:195], v[64:67], v[24:27], v[192:195]
v_add_u32 v5, s14, v8
s_waitcnt lgkmcnt(15)
v_mfma_f32_16x16x32_bf16 v[196:199], v[68:71], v[12:15], v[196:199]
v_mfma_f32_16x16x32_bf16 v[200:203], v[68:71], v[16:19], v[200:203]
v_mfma_f32_16x16x32_bf16 v[204:207], v[68:71], v[20:23], v[204:207]
v_mfma_f32_16x16x32_bf16 v[208:211], v[68:71], v[24:27], v[208:211]
s_waitcnt lgkmcnt(12)
v_mfma_f32_16x16x32_bf16 v[100:103], v[72:75], v[28:31], v[100:103]
v_mfma_f32_16x16x32_bf16 v[104:107], v[72:75], v[32:35], v[104:107]
v_mfma_f32_16x16x32_bf16 v[108:111], v[72:75], v[36:39], v[108:111]
v_mfma_f32_16x16x32_bf16 v[112:115], v[72:75], v[40:43], v[112:115]
s_waitcnt lgkmcnt(0)
s_barrier
ds_read_b128 v[12:15], v3 offset:0
v_mfma_f32_16x16x32_bf16 v[116:119], v[76:79], v[28:31], v[116:119]
ds_read_b64_tr_b16 v[44:45], v4 offset:16384
v_mfma_f32_16x16x32_bf16 v[120:123], v[76:79], v[32:35], v[120:123]
ds_read_b64_tr_b16 v[46:47], v4 offset:20480
v_mfma_f32_16x16x32_bf16 v[124:127], v[76:79], v[36:39], v[124:127]
ds_read_b128 v[16:19], v3 offset:256
v_mfma_f32_16x16x32_bf16 v[128:131], v[76:79], v[40:43], v[128:131]
ds_read_b128 v[20:23], v3 offset:4096
v_mfma_f32_16x16x32_bf16 v[132:135], v[80:83], v[28:31], v[132:135]
ds_read_b128 v[24:27], v3 offset:4352
v_mfma_f32_16x16x32_bf16 v[136:139], v[80:83], v[32:35], v[136:139]
ds_read_b64_tr_b16 v[48:49], v5 offset:16384
v_mfma_f32_16x16x32_bf16 v[140:143], v[80:83], v[36:39], v[140:143]
ds_read_b64_tr_b16 v[50:51], v5 offset:20480
v_mfma_f32_16x16x32_bf16 v[144:147], v[80:83], v[40:43], v[144:147]
ds_read_b64_tr_b16 v[52:53], v4 offset:16640
v_mfma_f32_16x16x32_bf16 v[148:151], v[84:87], v[28:31], v[148:151]
v_mfma_f32_16x16x32_bf16 v[152:155], v[84:87], v[32:35], v[152:155]
ds_read_b64_tr_b16 v[54:55], v4 offset:20736
v_mfma_f32_16x16x32_bf16 v[156:159], v[84:87], v[36:39], v[156:159]
ds_read_b64_tr_b16 v[56:57], v5 offset:16640
v_mfma_f32_16x16x32_bf16 v[160:163], v[84:87], v[40:43], v[160:163]
ds_read_b64_tr_b16 v[58:59], v5 offset:20736
v_mfma_f32_16x16x32_bf16 v[164:167], v[88:91], v[28:31], v[164:167]
ds_read_b64_tr_b16 v[60:61], v4 offset:16896
v_mfma_f32_16x16x32_bf16 v[168:171], v[88:91], v[32:35], v[168:171]
ds_read_b64_tr_b16 v[62:63], v4 offset:20992
v_mfma_f32_16x16x32_bf16 v[172:175], v[88:91], v[36:39], v[172:175]
ds_read_b64_tr_b16 v[64:65], v5 offset:16896
v_mfma_f32_16x16x32_bf16 v[176:179], v[88:91], v[40:43], v[176:179]
ds_read_b64_tr_b16 v[66:67], v5 offset:20992
v_mfma_f32_16x16x32_bf16 v[180:183], v[92:95], v[28:31], v[180:183]
ds_read_b64_tr_b16 v[68:69], v4 offset:17152
v_mfma_f32_16x16x32_bf16 v[184:187], v[92:95], v[32:35], v[184:187]
ds_read_b64_tr_b16 v[70:71], v4 offset:21248
v_mfma_f32_16x16x32_bf16 v[188:191], v[92:95], v[36:39], v[188:191]
v_mfma_f32_16x16x32_bf16 v[192:195], v[92:95], v[40:43], v[192:195]
v_mfma_f32_16x16x32_bf16 v[196:199], v[96:99], v[28:31], v[196:199]
v_mfma_f32_16x16x32_bf16 v[200:203], v[96:99], v[32:35], v[200:203]
v_mfma_f32_16x16x32_bf16 v[204:207], v[96:99], v[36:39], v[204:207]
s_sub_u32 s15, s15, 1
s_cmp_lg_u32 s15, 0
v_mfma_f32_16x16x32_bf16 v[208:211], v[96:99], v[40:43], v[208:211]
s_cbranch_scc1 FFN1_CLOOP
s_waitcnt lgkmcnt(0)
s_setprio 0
s_barrier
s_nop 7
s_mov_b32 s16, s6
s_mov_b32 s17, s7
s_add_u32 s16, s16, 25165824
s_addc_u32 s17, s17, 0
s_mov_b32 s18, 14680064
s_mov_b32 s19, 0x20000
v_bfe_u32 v9, v2, 5, 1
v_bfe_u32 v10, v2, 4, 1
v_and_b32 v11, 15, v2
v_lshrrev_b32 v1, 4, v2
v_lshlrev_b32 v3, 4, v11
v_lshl_add_u32 v3, v10, 9, v3
v_lshl_add_u32 v3, v9, 8, v3
s_mul_i32 s37, s33, 448
s_add_u32 s37, s37, 147456
v_lshlrev_b32 v4, 4, v1
v_add_u32 v4, s37, v4
s_lshl_b32 s37, s32, 8
s_add_u32 s37, s37, 147456
v_lshlrev_b32 v5, 2, v11
v_add_u32 v5, s37, v5
ds_read_b32 v12, v5 offset:2048
ds_read_b32 v20, v5 offset:2560
ds_read_b32 v14, v5 offset:2112
ds_read_b32 v22, v5 offset:2624
ds_read_b32 v16, v5 offset:2176
ds_read_b32 v24, v5 offset:2688
ds_read_b32 v18, v5 offset:2240
ds_read_b32 v26, v5 offset:2752
ds_read_b128 v[28:31], v4 offset:0
ds_read_b128 v[32:35], v4 offset:1024
s_lshl_b32 s36, s12, 2
s_lshl_b32 s37, s32, 1
s_add_u32 s36, s36, s37
s_mul_i32 s37, s36, 224
s_mul_i32 s38, s13, 14
s_add_u32 s37, s37, s38
s_mul_i32 s38, s33, 7
s_add_u32 s37, s37, s38
s_lshl_b32 s37, s37, 10
v_mov_b32 v6, 1.0
v_mov_b32 v7, 1.0
v_mov_b32 v44, 0xbdd2d3e8
v_mov_b32 v45, 0xbdd2d3e8
v_mov_b32 v46, 0xc0135761
v_mov_b32 v47, 0xc0135761
s_waitcnt lgkmcnt(2)
v_mov_b32 v13, v12
v_mov_b32 v21, v20
v_mov_b32 v15, v14
v_mov_b32 v23, v22
v_mov_b32 v17, v16
v_mov_b32 v25, v24
v_mov_b32 v19, v18
v_mov_b32 v27, v26
ds_read_b128 v[36:39], v4 offset:64
ds_read_b128 v[40:43], v4 offset:1088
s_waitcnt lgkmcnt(2)
v_pk_fma_f32 v[64:65], v[28:29], v[20:21], v[32:33]
v_pk_fma_f32 v[66:67], v[30:31], v[20:21], v[34:35]
v_pk_fma_f32 v[68:69], v[28:29], v[22:23], v[32:33]
v_pk_fma_f32 v[70:71], v[30:31], v[22:23], v[34:35]
v_pk_fma_f32 v[72:73], v[28:29], v[24:25], v[32:33]
v_pk_fma_f32 v[74:75], v[30:31], v[24:25], v[34:35]
v_pk_fma_f32 v[76:77], v[28:29], v[26:27], v[32:33]
v_pk_fma_f32 v[78:79], v[30:31], v[26:27], v[34:35]
v_pk_fma_f32 v[100:101], v[100:101], v[12:13], v[64:65]
v_pk_fma_f32 v[102:103], v[102:103], v[12:13], v[66:67]
v_pk_fma_f32 v[104:105], v[104:105], v[14:15], v[68:69]
v_pk_fma_f32 v[106:107], v[106:107], v[14:15], v[70:71]
v_pk_fma_f32 v[108:109], v[108:109], v[16:17], v[72:73]
v_pk_fma_f32 v[110:111], v[110:111], v[16:17], v[74:75]
v_pk_fma_f32 v[112:113], v[112:113], v[18:19], v[76:77]
v_pk_fma_f32 v[114:115], v[114:115], v[18:19], v[78:79]
v_pk_mul_f32 v[48:49], v[100:101], v[100:101]
v_pk_mul_f32 v[50:51], v[102:103], v[102:103]
v_pk_mul_f32 v[52:53], v[104:105], v[104:105]
v_pk_mul_f32 v[54:55], v[106:107], v[106:107]
v_pk_mul_f32 v[56:57], v[108:109], v[108:109]
v_pk_mul_f32 v[58:59], v[110:111], v[110:111]
v_pk_mul_f32 v[60:61], v[112:113], v[112:113]
v_pk_mul_f32 v[62:63], v[114:115], v[114:115]
v_pk_fma_f32 v[48:49], v[48:49], v[44:45], v[46:47]
v_pk_fma_f32 v[50:51], v[50:51], v[44:45], v[46:47]
v_pk_fma_f32 v[52:53], v[52:53], v[44:45], v[46:47]
v_pk_fma_f32 v[54:55], v[54:55], v[44:45], v[46:47]
v_pk_fma_f32 v[56:57], v[56:57], v[44:45], v[46:47]
v_pk_fma_f32 v[58:59], v[58:59], v[44:45], v[46:47]
v_pk_fma_f32 v[60:61], v[60:61], v[44:45], v[46:47]
v_pk_fma_f32 v[62:63], v[62:63], v[44:45], v[46:47]
v_pk_mul_f32 v[48:49], v[48:49], v[100:101]
v_pk_mul_f32 v[50:51], v[50:51], v[102:103]
v_pk_mul_f32 v[52:53], v[52:53], v[104:105]
v_pk_mul_f32 v[54:55], v[54:55], v[106:107]
v_pk_mul_f32 v[56:57], v[56:57], v[108:109]
v_pk_mul_f32 v[58:59], v[58:59], v[110:111]
v_pk_mul_f32 v[60:61], v[60:61], v[112:113]
v_pk_mul_f32 v[62:63], v[62:63], v[114:115]
v_exp_f32 v48, v48
v_exp_f32 v49, v49
v_exp_f32 v50, v50
v_exp_f32 v51, v51
v_exp_f32 v52, v52
v_exp_f32 v53, v53
v_exp_f32 v54, v54
v_exp_f32 v55, v55
v_exp_f32 v56, v56
v_exp_f32 v57, v57
v_exp_f32 v58, v58
v_exp_f32 v59, v59
v_exp_f32 v60, v60
v_exp_f32 v61, v61
v_exp_f32 v62, v62
v_exp_f32 v63, v63
v_pk_add_f32 v[48:49], v[48:49], v[6:7]
v_pk_add_f32 v[50:51], v[50:51], v[6:7]
v_pk_add_f32 v[52:53], v[52:53], v[6:7]
v_pk_add_f32 v[54:55], v[54:55], v[6:7]
v_pk_add_f32 v[56:57], v[56:57], v[6:7]
v_pk_add_f32 v[58:59], v[58:59], v[6:7]
v_pk_add_f32 v[60:61], v[60:61], v[6:7]
v_pk_add_f32 v[62:63], v[62:63], v[6:7]
v_rcp_f32 v48, v48
v_rcp_f32 v49, v49
v_rcp_f32 v50, v50
v_rcp_f32 v51, v51
v_rcp_f32 v52, v52
v_rcp_f32 v53, v53
v_rcp_f32 v54, v54
v_rcp_f32 v55, v55
v_rcp_f32 v56, v56
v_rcp_f32 v57, v57
v_rcp_f32 v58, v58
v_rcp_f32 v59, v59
v_rcp_f32 v60, v60
v_rcp_f32 v61, v61
v_rcp_f32 v62, v62
v_rcp_f32 v63, v63
v_pk_mul_f32 v[100:101], v[100:101], v[48:49]
v_pk_mul_f32 v[102:103], v[102:103], v[50:51]
v_pk_mul_f32 v[104:105], v[104:105], v[52:53]
v_pk_mul_f32 v[106:107], v[106:107], v[54:55]
v_pk_mul_f32 v[108:109], v[108:109], v[56:57]
v_pk_mul_f32 v[110:111], v[110:111], v[58:59]
v_pk_mul_f32 v[112:113], v[112:113], v[60:61]
v_pk_mul_f32 v[114:115], v[114:115], v[62:63]
v_cvt_pk_bf16_f32 v80, v100, v101
v_cvt_pk_bf16_f32 v81, v102, v103
v_cvt_pk_bf16_f32 v82, v104, v105
v_cvt_pk_bf16_f32 v83, v106, v107
v_cvt_pk_bf16_f32 v84, v108, v109
v_cvt_pk_bf16_f32 v85, v110, v111
v_cvt_pk_bf16_f32 v86, v112, v113
v_cvt_pk_bf16_f32 v87, v114, v115
s_nop 0
v_permlane32_swap_b32 v80, v82
v_permlane32_swap_b32 v81, v83
v_permlane32_swap_b32 v84, v86
v_permlane32_swap_b32 v85, v87
s_add_u32 s38, s37, 0
buffer_store_dwordx4 v[80:83], v3, s[16:19], s38 offen sc1
s_add_u32 s38, s37, 229376
buffer_store_dwordx4 v[84:87], v3, s[16:19], s38 offen sc1
ds_read_b128 v[28:31], v4 offset:128
ds_read_b128 v[32:35], v4 offset:1152
s_waitcnt lgkmcnt(2)
v_pk_fma_f32 v[64:65], v[36:37], v[20:21], v[40:41]
v_pk_fma_f32 v[66:67], v[38:39], v[20:21], v[42:43]
v_pk_fma_f32 v[68:69], v[36:37], v[22:23], v[40:41]
v_pk_fma_f32 v[70:71], v[38:39], v[22:23], v[42:43]
v_pk_fma_f32 v[72:73], v[36:37], v[24:25], v[40:41]
v_pk_fma_f32 v[74:75], v[38:39], v[24:25], v[42:43]
v_pk_fma_f32 v[76:77], v[36:37], v[26:27], v[40:41]
v_pk_fma_f32 v[78:79], v[38:39], v[26:27], v[42:43]
v_pk_fma_f32 v[116:117], v[116:117], v[12:13], v[64:65]
v_pk_fma_f32 v[118:119], v[118:119], v[12:13], v[66:67]
v_pk_fma_f32 v[120:121], v[120:121], v[14:15], v[68:69]
v_pk_fma_f32 v[122:123], v[122:123], v[14:15], v[70:71]
v_pk_fma_f32 v[124:125], v[124:125], v[16:17], v[72:73]
v_pk_fma_f32 v[126:127], v[126:127], v[16:17], v[74:75]
v_pk_fma_f32 v[128:129], v[128:129], v[18:19], v[76:77]
v_pk_fma_f32 v[130:131], v[130:131], v[18:19], v[78:79]
v_pk_mul_f32 v[48:49], v[116:117], v[116:117]
v_pk_mul_f32 v[50:51], v[118:119], v[118:119]
v_pk_mul_f32 v[52:53], v[120:121], v[120:121]
v_pk_mul_f32 v[54:55], v[122:123], v[122:123]
v_pk_mul_f32 v[56:57], v[124:125], v[124:125]
v_pk_mul_f32 v[58:59], v[126:127], v[126:127]
v_pk_mul_f32 v[60:61], v[128:129], v[128:129]
v_pk_mul_f32 v[62:63], v[130:131], v[130:131]
v_pk_fma_f32 v[48:49], v[48:49], v[44:45], v[46:47]
v_pk_fma_f32 v[50:51], v[50:51], v[44:45], v[46:47]
v_pk_fma_f32 v[52:53], v[52:53], v[44:45], v[46:47]
v_pk_fma_f32 v[54:55], v[54:55], v[44:45], v[46:47]
v_pk_fma_f32 v[56:57], v[56:57], v[44:45], v[46:47]
v_pk_fma_f32 v[58:59], v[58:59], v[44:45], v[46:47]
v_pk_fma_f32 v[60:61], v[60:61], v[44:45], v[46:47]
v_pk_fma_f32 v[62:63], v[62:63], v[44:45], v[46:47]
v_pk_mul_f32 v[48:49], v[48:49], v[116:117]
v_pk_mul_f32 v[50:51], v[50:51], v[118:119]
v_pk_mul_f32 v[52:53], v[52:53], v[120:121]
v_pk_mul_f32 v[54:55], v[54:55], v[122:123]
v_pk_mul_f32 v[56:57], v[56:57], v[124:125]
v_pk_mul_f32 v[58:59], v[58:59], v[126:127]
v_pk_mul_f32 v[60:61], v[60:61], v[128:129]
v_pk_mul_f32 v[62:63], v[62:63], v[130:131]
v_exp_f32 v48, v48
v_exp_f32 v49, v49
v_exp_f32 v50, v50
v_exp_f32 v51, v51
v_exp_f32 v52, v52
v_exp_f32 v53, v53
v_exp_f32 v54, v54
v_exp_f32 v55, v55
v_exp_f32 v56, v56
v_exp_f32 v57, v57
v_exp_f32 v58, v58
v_exp_f32 v59, v59
v_exp_f32 v60, v60
v_exp_f32 v61, v61
v_exp_f32 v62, v62
v_exp_f32 v63, v63
v_pk_add_f32 v[48:49], v[48:49], v[6:7]
v_pk_add_f32 v[50:51], v[50:51], v[6:7]
v_pk_add_f32 v[52:53], v[52:53], v[6:7]
v_pk_add_f32 v[54:55], v[54:55], v[6:7]
v_pk_add_f32 v[56:57], v[56:57], v[6:7]
v_pk_add_f32 v[58:59], v[58:59], v[6:7]
v_pk_add_f32 v[60:61], v[60:61], v[6:7]
v_pk_add_f32 v[62:63], v[62:63], v[6:7]
v_rcp_f32 v48, v48
v_rcp_f32 v49, v49
v_rcp_f32 v50, v50
v_rcp_f32 v51, v51
v_rcp_f32 v52, v52
v_rcp_f32 v53, v53
v_rcp_f32 v54, v54
v_rcp_f32 v55, v55
v_rcp_f32 v56, v56
v_rcp_f32 v57, v57
v_rcp_f32 v58, v58
v_rcp_f32 v59, v59
v_rcp_f32 v60, v60
v_rcp_f32 v61, v61
v_rcp_f32 v62, v62
v_rcp_f32 v63, v63
v_pk_mul_f32 v[116:117], v[116:117], v[48:49]
v_pk_mul_f32 v[118:119], v[118:119], v[50:51]
v_pk_mul_f32 v[120:121], v[120:121], v[52:53]
v_pk_mul_f32 v[122:123], v[122:123], v[54:55]
v_pk_mul_f32 v[124:125], v[124:125], v[56:57]
v_pk_mul_f32 v[126:127], v[126:127], v[58:59]
v_pk_mul_f32 v[128:129], v[128:129], v[60:61]
v_pk_mul_f32 v[130:131], v[130:131], v[62:63]
v_cvt_pk_bf16_f32 v88, v116, v117
v_cvt_pk_bf16_f32 v89, v118, v119
v_cvt_pk_bf16_f32 v90, v120, v121
v_cvt_pk_bf16_f32 v91, v122, v123
v_cvt_pk_bf16_f32 v92, v124, v125
v_cvt_pk_bf16_f32 v93, v126, v127
v_cvt_pk_bf16_f32 v94, v128, v129
v_cvt_pk_bf16_f32 v95, v130, v131
s_nop 0
v_permlane32_swap_b32 v88, v90
v_permlane32_swap_b32 v89, v91
v_permlane32_swap_b32 v92, v94
v_permlane32_swap_b32 v93, v95
s_add_u32 s38, s37, 1024
buffer_store_dwordx4 v[88:91], v3, s[16:19], s38 offen sc1
s_add_u32 s38, s37, 230400
buffer_store_dwordx4 v[92:95], v3, s[16:19], s38 offen sc1
ds_read_b128 v[36:39], v4 offset:192
ds_read_b128 v[40:43], v4 offset:1216
s_waitcnt lgkmcnt(2)
v_pk_fma_f32 v[64:65], v[28:29], v[20:21], v[32:33]
v_pk_fma_f32 v[66:67], v[30:31], v[20:21], v[34:35]
v_pk_fma_f32 v[68:69], v[28:29], v[22:23], v[32:33]
v_pk_fma_f32 v[70:71], v[30:31], v[22:23], v[34:35]
v_pk_fma_f32 v[72:73], v[28:29], v[24:25], v[32:33]
v_pk_fma_f32 v[74:75], v[30:31], v[24:25], v[34:35]
v_pk_fma_f32 v[76:77], v[28:29], v[26:27], v[32:33]
v_pk_fma_f32 v[78:79], v[30:31], v[26:27], v[34:35]
v_pk_fma_f32 v[132:133], v[132:133], v[12:13], v[64:65]
v_pk_fma_f32 v[134:135], v[134:135], v[12:13], v[66:67]
v_pk_fma_f32 v[136:137], v[136:137], v[14:15], v[68:69]
v_pk_fma_f32 v[138:139], v[138:139], v[14:15], v[70:71]
v_pk_fma_f32 v[140:141], v[140:141], v[16:17], v[72:73]
v_pk_fma_f32 v[142:143], v[142:143], v[16:17], v[74:75]
v_pk_fma_f32 v[144:145], v[144:145], v[18:19], v[76:77]
v_pk_fma_f32 v[146:147], v[146:147], v[18:19], v[78:79]
v_pk_mul_f32 v[48:49], v[132:133], v[132:133]
v_pk_mul_f32 v[50:51], v[134:135], v[134:135]
v_pk_mul_f32 v[52:53], v[136:137], v[136:137]
v_pk_mul_f32 v[54:55], v[138:139], v[138:139]
v_pk_mul_f32 v[56:57], v[140:141], v[140:141]
v_pk_mul_f32 v[58:59], v[142:143], v[142:143]
v_pk_mul_f32 v[60:61], v[144:145], v[144:145]
v_pk_mul_f32 v[62:63], v[146:147], v[146:147]
v_pk_fma_f32 v[48:49], v[48:49], v[44:45], v[46:47]
v_pk_fma_f32 v[50:51], v[50:51], v[44:45], v[46:47]
v_pk_fma_f32 v[52:53], v[52:53], v[44:45], v[46:47]
v_pk_fma_f32 v[54:55], v[54:55], v[44:45], v[46:47]
v_pk_fma_f32 v[56:57], v[56:57], v[44:45], v[46:47]
v_pk_fma_f32 v[58:59], v[58:59], v[44:45], v[46:47]
v_pk_fma_f32 v[60:61], v[60:61], v[44:45], v[46:47]
v_pk_fma_f32 v[62:63], v[62:63], v[44:45], v[46:47]
v_pk_mul_f32 v[48:49], v[48:49], v[132:133]
v_pk_mul_f32 v[50:51], v[50:51], v[134:135]
v_pk_mul_f32 v[52:53], v[52:53], v[136:137]
v_pk_mul_f32 v[54:55], v[54:55], v[138:139]
v_pk_mul_f32 v[56:57], v[56:57], v[140:141]
v_pk_mul_f32 v[58:59], v[58:59], v[142:143]
v_pk_mul_f32 v[60:61], v[60:61], v[144:145]
v_pk_mul_f32 v[62:63], v[62:63], v[146:147]
v_exp_f32 v48, v48
v_exp_f32 v49, v49
v_exp_f32 v50, v50
v_exp_f32 v51, v51
v_exp_f32 v52, v52
v_exp_f32 v53, v53
v_exp_f32 v54, v54
v_exp_f32 v55, v55
v_exp_f32 v56, v56
v_exp_f32 v57, v57
v_exp_f32 v58, v58
v_exp_f32 v59, v59
v_exp_f32 v60, v60
v_exp_f32 v61, v61
v_exp_f32 v62, v62
v_exp_f32 v63, v63
v_pk_add_f32 v[48:49], v[48:49], v[6:7]
v_pk_add_f32 v[50:51], v[50:51], v[6:7]
v_pk_add_f32 v[52:53], v[52:53], v[6:7]
v_pk_add_f32 v[54:55], v[54:55], v[6:7]
v_pk_add_f32 v[56:57], v[56:57], v[6:7]
v_pk_add_f32 v[58:59], v[58:59], v[6:7]
v_pk_add_f32 v[60:61], v[60:61], v[6:7]
v_pk_add_f32 v[62:63], v[62:63], v[6:7]
v_rcp_f32 v48, v48
v_rcp_f32 v49, v49
v_rcp_f32 v50, v50
v_rcp_f32 v51, v51
v_rcp_f32 v52, v52
v_rcp_f32 v53, v53
v_rcp_f32 v54, v54
v_rcp_f32 v55, v55
v_rcp_f32 v56, v56
v_rcp_f32 v57, v57
v_rcp_f32 v58, v58
v_rcp_f32 v59, v59
v_rcp_f32 v60, v60
v_rcp_f32 v61, v61
v_rcp_f32 v62, v62
v_rcp_f32 v63, v63
v_pk_mul_f32 v[132:133], v[132:133], v[48:49]
v_pk_mul_f32 v[134:135], v[134:135], v[50:51]
v_pk_mul_f32 v[136:137], v[136:137], v[52:53]
v_pk_mul_f32 v[138:139], v[138:139], v[54:55]
v_pk_mul_f32 v[140:141], v[140:141], v[56:57]
v_pk_mul_f32 v[142:143], v[142:143], v[58:59]
v_pk_mul_f32 v[144:145], v[144:145], v[60:61]
v_pk_mul_f32 v[146:147], v[146:147], v[62:63]
v_cvt_pk_bf16_f32 v80, v132, v133
v_cvt_pk_bf16_f32 v81, v134, v135
v_cvt_pk_bf16_f32 v82, v136, v137
v_cvt_pk_bf16_f32 v83, v138, v139
v_cvt_pk_bf16_f32 v84, v140, v141
v_cvt_pk_bf16_f32 v85, v142, v143
v_cvt_pk_bf16_f32 v86, v144, v145
v_cvt_pk_bf16_f32 v87, v146, v147
s_nop 0
v_permlane32_swap_b32 v80, v82
v_permlane32_swap_b32 v81, v83
v_permlane32_swap_b32 v84, v86
v_permlane32_swap_b32 v85, v87
s_add_u32 s38, s37, 2048
buffer_store_dwordx4 v[80:83], v3, s[16:19], s38 offen sc1
s_add_u32 s38, s37, 231424
buffer_store_dwordx4 v[84:87], v3, s[16:19], s38 offen sc1
ds_read_b128 v[28:31], v4 offset:256
ds_read_b128 v[32:35], v4 offset:1280
s_waitcnt lgkmcnt(2)
v_pk_fma_f32 v[64:65], v[36:37], v[20:21], v[40:41]
v_pk_fma_f32 v[66:67], v[38:39], v[20:21], v[42:43]
v_pk_fma_f32 v[68:69], v[36:37], v[22:23], v[40:41]
v_pk_fma_f32 v[70:71], v[38:39], v[22:23], v[42:43]
v_pk_fma_f32 v[72:73], v[36:37], v[24:25], v[40:41]
v_pk_fma_f32 v[74:75], v[38:39], v[24:25], v[42:43]
v_pk_fma_f32 v[76:77], v[36:37], v[26:27], v[40:41]
v_pk_fma_f32 v[78:79], v[38:39], v[26:27], v[42:43]
v_pk_fma_f32 v[148:149], v[148:149], v[12:13], v[64:65]
v_pk_fma_f32 v[150:151], v[150:151], v[12:13], v[66:67]
v_pk_fma_f32 v[152:153], v[152:153], v[14:15], v[68:69]
v_pk_fma_f32 v[154:155], v[154:155], v[14:15], v[70:71]
v_pk_fma_f32 v[156:157], v[156:157], v[16:17], v[72:73]
v_pk_fma_f32 v[158:159], v[158:159], v[16:17], v[74:75]
v_pk_fma_f32 v[160:161], v[160:161], v[18:19], v[76:77]
v_pk_fma_f32 v[162:163], v[162:163], v[18:19], v[78:79]
v_pk_mul_f32 v[48:49], v[148:149], v[148:149]
v_pk_mul_f32 v[50:51], v[150:151], v[150:151]
v_pk_mul_f32 v[52:53], v[152:153], v[152:153]
v_pk_mul_f32 v[54:55], v[154:155], v[154:155]
v_pk_mul_f32 v[56:57], v[156:157], v[156:157]
v_pk_mul_f32 v[58:59], v[158:159], v[158:159]
v_pk_mul_f32 v[60:61], v[160:161], v[160:161]
v_pk_mul_f32 v[62:63], v[162:163], v[162:163]
v_pk_fma_f32 v[48:49], v[48:49], v[44:45], v[46:47]
v_pk_fma_f32 v[50:51], v[50:51], v[44:45], v[46:47]
v_pk_fma_f32 v[52:53], v[52:53], v[44:45], v[46:47]
v_pk_fma_f32 v[54:55], v[54:55], v[44:45], v[46:47]
v_pk_fma_f32 v[56:57], v[56:57], v[44:45], v[46:47]
v_pk_fma_f32 v[58:59], v[58:59], v[44:45], v[46:47]
v_pk_fma_f32 v[60:61], v[60:61], v[44:45], v[46:47]
v_pk_fma_f32 v[62:63], v[62:63], v[44:45], v[46:47]
v_pk_mul_f32 v[48:49], v[48:49], v[148:149]
v_pk_mul_f32 v[50:51], v[50:51], v[150:151]
v_pk_mul_f32 v[52:53], v[52:53], v[152:153]
v_pk_mul_f32 v[54:55], v[54:55], v[154:155]
v_pk_mul_f32 v[56:57], v[56:57], v[156:157]
v_pk_mul_f32 v[58:59], v[58:59], v[158:159]
v_pk_mul_f32 v[60:61], v[60:61], v[160:161]
v_pk_mul_f32 v[62:63], v[62:63], v[162:163]
v_exp_f32 v48, v48
v_exp_f32 v49, v49
v_exp_f32 v50, v50
v_exp_f32 v51, v51
v_exp_f32 v52, v52
v_exp_f32 v53, v53
v_exp_f32 v54, v54
v_exp_f32 v55, v55
v_exp_f32 v56, v56
v_exp_f32 v57, v57
v_exp_f32 v58, v58
v_exp_f32 v59, v59
v_exp_f32 v60, v60
v_exp_f32 v61, v61
v_exp_f32 v62, v62
v_exp_f32 v63, v63
v_pk_add_f32 v[48:49], v[48:49], v[6:7]
v_pk_add_f32 v[50:51], v[50:51], v[6:7]
v_pk_add_f32 v[52:53], v[52:53], v[6:7]
v_pk_add_f32 v[54:55], v[54:55], v[6:7]
v_pk_add_f32 v[56:57], v[56:57], v[6:7]
v_pk_add_f32 v[58:59], v[58:59], v[6:7]
v_pk_add_f32 v[60:61], v[60:61], v[6:7]
v_pk_add_f32 v[62:63], v[62:63], v[6:7]
v_rcp_f32 v48, v48
v_rcp_f32 v49, v49
v_rcp_f32 v50, v50
v_rcp_f32 v51, v51
v_rcp_f32 v52, v52
v_rcp_f32 v53, v53
v_rcp_f32 v54, v54
v_rcp_f32 v55, v55
v_rcp_f32 v56, v56
v_rcp_f32 v57, v57
v_rcp_f32 v58, v58
v_rcp_f32 v59, v59
v_rcp_f32 v60, v60
v_rcp_f32 v61, v61
v_rcp_f32 v62, v62
v_rcp_f32 v63, v63
v_pk_mul_f32 v[148:149], v[148:149], v[48:49]
v_pk_mul_f32 v[150:151], v[150:151], v[50:51]
v_pk_mul_f32 v[152:153], v[152:153], v[52:53]
v_pk_mul_f32 v[154:155], v[154:155], v[54:55]
v_pk_mul_f32 v[156:157], v[156:157], v[56:57]
v_pk_mul_f32 v[158:159], v[158:159], v[58:59]
v_pk_mul_f32 v[160:161], v[160:161], v[60:61]
v_pk_mul_f32 v[162:163], v[162:163], v[62:63]
v_cvt_pk_bf16_f32 v88, v148, v149
v_cvt_pk_bf16_f32 v89, v150, v151
v_cvt_pk_bf16_f32 v90, v152, v153
v_cvt_pk_bf16_f32 v91, v154, v155
v_cvt_pk_bf16_f32 v92, v156, v157
v_cvt_pk_bf16_f32 v93, v158, v159
v_cvt_pk_bf16_f32 v94, v160, v161
v_cvt_pk_bf16_f32 v95, v162, v163
s_nop 0
v_permlane32_swap_b32 v88, v90
v_permlane32_swap_b32 v89, v91
v_permlane32_swap_b32 v92, v94
v_permlane32_swap_b32 v93, v95
s_add_u32 s38, s37, 3072
buffer_store_dwordx4 v[88:91], v3, s[16:19], s38 offen sc1
s_add_u32 s38, s37, 232448
buffer_store_dwordx4 v[92:95], v3, s[16:19], s38 offen sc1
ds_read_b128 v[36:39], v4 offset:320
ds_read_b128 v[40:43], v4 offset:1344
s_waitcnt lgkmcnt(2)
v_pk_fma_f32 v[64:65], v[28:29], v[20:21], v[32:33]
v_pk_fma_f32 v[66:67], v[30:31], v[20:21], v[34:35]
v_pk_fma_f32 v[68:69], v[28:29], v[22:23], v[32:33]
v_pk_fma_f32 v[70:71], v[30:31], v[22:23], v[34:35]
v_pk_fma_f32 v[72:73], v[28:29], v[24:25], v[32:33]
v_pk_fma_f32 v[74:75], v[30:31], v[24:25], v[34:35]
v_pk_fma_f32 v[76:77], v[28:29], v[26:27], v[32:33]
v_pk_fma_f32 v[78:79], v[30:31], v[26:27], v[34:35]
v_pk_fma_f32 v[164:165], v[164:165], v[12:13], v[64:65]
v_pk_fma_f32 v[166:167], v[166:167], v[12:13], v[66:67]
v_pk_fma_f32 v[168:169], v[168:169], v[14:15], v[68:69]
v_pk_fma_f32 v[170:171], v[170:171], v[14:15], v[70:71]
v_pk_fma_f32 v[172:173], v[172:173], v[16:17], v[72:73]
v_pk_fma_f32 v[174:175], v[174:175], v[16:17], v[74:75]
v_pk_fma_f32 v[176:177], v[176:177], v[18:19], v[76:77]
v_pk_fma_f32 v[178:179], v[178:179], v[18:19], v[78:79]
v_pk_mul_f32 v[48:49], v[164:165], v[164:165]
v_pk_mul_f32 v[50:51], v[166:167], v[166:167]
v_pk_mul_f32 v[52:53], v[168:169], v[168:169]
v_pk_mul_f32 v[54:55], v[170:171], v[170:171]
v_pk_mul_f32 v[56:57], v[172:173], v[172:173]
v_pk_mul_f32 v[58:59], v[174:175], v[174:175]
v_pk_mul_f32 v[60:61], v[176:177], v[176:177]
v_pk_mul_f32 v[62:63], v[178:179], v[178:179]
v_pk_fma_f32 v[48:49], v[48:49], v[44:45], v[46:47]
v_pk_fma_f32 v[50:51], v[50:51], v[44:45], v[46:47]
v_pk_fma_f32 v[52:53], v[52:53], v[44:45], v[46:47]
v_pk_fma_f32 v[54:55], v[54:55], v[44:45], v[46:47]
v_pk_fma_f32 v[56:57], v[56:57], v[44:45], v[46:47]
v_pk_fma_f32 v[58:59], v[58:59], v[44:45], v[46:47]
v_pk_fma_f32 v[60:61], v[60:61], v[44:45], v[46:47]
v_pk_fma_f32 v[62:63], v[62:63], v[44:45], v[46:47]
v_pk_mul_f32 v[48:49], v[48:49], v[164:165]
v_pk_mul_f32 v[50:51], v[50:51], v[166:167]
v_pk_mul_f32 v[52:53], v[52:53], v[168:169]
v_pk_mul_f32 v[54:55], v[54:55], v[170:171]
v_pk_mul_f32 v[56:57], v[56:57], v[172:173]
v_pk_mul_f32 v[58:59], v[58:59], v[174:175]
v_pk_mul_f32 v[60:61], v[60:61], v[176:177]
v_pk_mul_f32 v[62:63], v[62:63], v[178:179]
v_exp_f32 v48, v48
v_exp_f32 v49, v49
v_exp_f32 v50, v50
v_exp_f32 v51, v51
v_exp_f32 v52, v52
v_exp_f32 v53, v53
v_exp_f32 v54, v54
v_exp_f32 v55, v55
v_exp_f32 v56, v56
v_exp_f32 v57, v57
v_exp_f32 v58, v58
v_exp_f32 v59, v59
v_exp_f32 v60, v60
v_exp_f32 v61, v61
v_exp_f32 v62, v62
v_exp_f32 v63, v63
v_pk_add_f32 v[48:49], v[48:49], v[6:7]
v_pk_add_f32 v[50:51], v[50:51], v[6:7]
v_pk_add_f32 v[52:53], v[52:53], v[6:7]
v_pk_add_f32 v[54:55], v[54:55], v[6:7]
v_pk_add_f32 v[56:57], v[56:57], v[6:7]
v_pk_add_f32 v[58:59], v[58:59], v[6:7]
v_pk_add_f32 v[60:61], v[60:61], v[6:7]
v_pk_add_f32 v[62:63], v[62:63], v[6:7]
v_rcp_f32 v48, v48
v_rcp_f32 v49, v49
v_rcp_f32 v50, v50
v_rcp_f32 v51, v51
v_rcp_f32 v52, v52
v_rcp_f32 v53, v53
v_rcp_f32 v54, v54
v_rcp_f32 v55, v55
v_rcp_f32 v56, v56
v_rcp_f32 v57, v57
v_rcp_f32 v58, v58
v_rcp_f32 v59, v59
v_rcp_f32 v60, v60
v_rcp_f32 v61, v61
v_rcp_f32 v62, v62
v_rcp_f32 v63, v63
v_pk_mul_f32 v[164:165], v[164:165], v[48:49]
v_pk_mul_f32 v[166:167], v[166:167], v[50:51]
v_pk_mul_f32 v[168:169], v[168:169], v[52:53]
v_pk_mul_f32 v[170:171], v[170:171], v[54:55]
v_pk_mul_f32 v[172:173], v[172:173], v[56:57]
v_pk_mul_f32 v[174:175], v[174:175], v[58:59]
v_pk_mul_f32 v[176:177], v[176:177], v[60:61]
v_pk_mul_f32 v[178:179], v[178:179], v[62:63]
v_cvt_pk_bf16_f32 v80, v164, v165
v_cvt_pk_bf16_f32 v81, v166, v167
v_cvt_pk_bf16_f32 v82, v168, v169
v_cvt_pk_bf16_f32 v83, v170, v171
v_cvt_pk_bf16_f32 v84, v172, v173
v_cvt_pk_bf16_f32 v85, v174, v175
v_cvt_pk_bf16_f32 v86, v176, v177
v_cvt_pk_bf16_f32 v87, v178, v179
s_nop 0
v_permlane32_swap_b32 v80, v82
v_permlane32_swap_b32 v81, v83
v_permlane32_swap_b32 v84, v86
v_permlane32_swap_b32 v85, v87
s_add_u32 s38, s37, 4096
buffer_store_dwordx4 v[80:83], v3, s[16:19], s38 offen sc1
s_add_u32 s38, s37, 233472
buffer_store_dwordx4 v[84:87], v3, s[16:19], s38 offen sc1
ds_read_b128 v[28:31], v4 offset:384
ds_read_b128 v[32:35], v4 offset:1408
s_waitcnt lgkmcnt(2)
v_pk_fma_f32 v[64:65], v[36:37], v[20:21], v[40:41]
v_pk_fma_f32 v[66:67], v[38:39], v[20:21], v[42:43]
v_pk_fma_f32 v[68:69], v[36:37], v[22:23], v[40:41]
v_pk_fma_f32 v[70:71], v[38:39], v[22:23], v[42:43]
v_pk_fma_f32 v[72:73], v[36:37], v[24:25], v[40:41]
v_pk_fma_f32 v[74:75], v[38:39], v[24:25], v[42:43]
v_pk_fma_f32 v[76:77], v[36:37], v[26:27], v[40:41]
v_pk_fma_f32 v[78:79], v[38:39], v[26:27], v[42:43]
v_pk_fma_f32 v[180:181], v[180:181], v[12:13], v[64:65]
v_pk_fma_f32 v[182:183], v[182:183], v[12:13], v[66:67]
v_pk_fma_f32 v[184:185], v[184:185], v[14:15], v[68:69]
v_pk_fma_f32 v[186:187], v[186:187], v[14:15], v[70:71]
v_pk_fma_f32 v[188:189], v[188:189], v[16:17], v[72:73]
v_pk_fma_f32 v[190:191], v[190:191], v[16:17], v[74:75]
v_pk_fma_f32 v[192:193], v[192:193], v[18:19], v[76:77]
v_pk_fma_f32 v[194:195], v[194:195], v[18:19], v[78:79]
v_pk_mul_f32 v[48:49], v[180:181], v[180:181]
v_pk_mul_f32 v[50:51], v[182:183], v[182:183]
v_pk_mul_f32 v[52:53], v[184:185], v[184:185]
v_pk_mul_f32 v[54:55], v[186:187], v[186:187]
v_pk_mul_f32 v[56:57], v[188:189], v[188:189]
v_pk_mul_f32 v[58:59], v[190:191], v[190:191]
v_pk_mul_f32 v[60:61], v[192:193], v[192:193]
v_pk_mul_f32 v[62:63], v[194:195], v[194:195]
v_pk_fma_f32 v[48:49], v[48:49], v[44:45], v[46:47]
v_pk_fma_f32 v[50:51], v[50:51], v[44:45], v[46:47]
v_pk_fma_f32 v[52:53], v[52:53], v[44:45], v[46:47]
v_pk_fma_f32 v[54:55], v[54:55], v[44:45], v[46:47]
v_pk_fma_f32 v[56:57], v[56:57], v[44:45], v[46:47]
v_pk_fma_f32 v[58:59], v[58:59], v[44:45], v[46:47]
v_pk_fma_f32 v[60:61], v[60:61], v[44:45], v[46:47]
v_pk_fma_f32 v[62:63], v[62:63], v[44:45], v[46:47]
v_pk_mul_f32 v[48:49], v[48:49], v[180:181]
v_pk_mul_f32 v[50:51], v[50:51], v[182:183]
v_pk_mul_f32 v[52:53], v[52:53], v[184:185]
v_pk_mul_f32 v[54:55], v[54:55], v[186:187]
v_pk_mul_f32 v[56:57], v[56:57], v[188:189]
v_pk_mul_f32 v[58:59], v[58:59], v[190:191]
v_pk_mul_f32 v[60:61], v[60:61], v[192:193]
v_pk_mul_f32 v[62:63], v[62:63], v[194:195]
v_exp_f32 v48, v48
v_exp_f32 v49, v49
v_exp_f32 v50, v50
v_exp_f32 v51, v51
v_exp_f32 v52, v52
v_exp_f32 v53, v53
v_exp_f32 v54, v54
v_exp_f32 v55, v55
v_exp_f32 v56, v56
v_exp_f32 v57, v57
v_exp_f32 v58, v58
v_exp_f32 v59, v59
v_exp_f32 v60, v60
v_exp_f32 v61, v61
v_exp_f32 v62, v62
v_exp_f32 v63, v63
v_pk_add_f32 v[48:49], v[48:49], v[6:7]
v_pk_add_f32 v[50:51], v[50:51], v[6:7]
v_pk_add_f32 v[52:53], v[52:53], v[6:7]
v_pk_add_f32 v[54:55], v[54:55], v[6:7]
v_pk_add_f32 v[56:57], v[56:57], v[6:7]
v_pk_add_f32 v[58:59], v[58:59], v[6:7]
v_pk_add_f32 v[60:61], v[60:61], v[6:7]
v_pk_add_f32 v[62:63], v[62:63], v[6:7]
v_rcp_f32 v48, v48
v_rcp_f32 v49, v49
v_rcp_f32 v50, v50
v_rcp_f32 v51, v51
v_rcp_f32 v52, v52
v_rcp_f32 v53, v53
v_rcp_f32 v54, v54
v_rcp_f32 v55, v55
v_rcp_f32 v56, v56
v_rcp_f32 v57, v57
v_rcp_f32 v58, v58
v_rcp_f32 v59, v59
v_rcp_f32 v60, v60
v_rcp_f32 v61, v61
v_rcp_f32 v62, v62
v_rcp_f32 v63, v63
v_pk_mul_f32 v[180:181], v[180:181], v[48:49]
v_pk_mul_f32 v[182:183], v[182:183], v[50:51]
v_pk_mul_f32 v[184:185], v[184:185], v[52:53]
v_pk_mul_f32 v[186:187], v[186:187], v[54:55]
v_pk_mul_f32 v[188:189], v[188:189], v[56:57]
v_pk_mul_f32 v[190:191], v[190:191], v[58:59]
v_pk_mul_f32 v[192:193], v[192:193], v[60:61]
v_pk_mul_f32 v[194:195], v[194:195], v[62:63]
v_cvt_pk_bf16_f32 v88, v180, v181
v_cvt_pk_bf16_f32 v89, v182, v183
v_cvt_pk_bf16_f32 v90, v184, v185
v_cvt_pk_bf16_f32 v91, v186, v187
v_cvt_pk_bf16_f32 v92, v188, v189
v_cvt_pk_bf16_f32 v93, v190, v191
v_cvt_pk_bf16_f32 v94, v192, v193
v_cvt_pk_bf16_f32 v95, v194, v195
s_nop 0
v_permlane32_swap_b32 v88, v90
v_permlane32_swap_b32 v89, v91
v_permlane32_swap_b32 v92, v94
v_permlane32_swap_b32 v93, v95
s_add_u32 s38, s37, 5120
buffer_store_dwordx4 v[88:91], v3, s[16:19], s38 offen sc1
s_add_u32 s38, s37, 234496
buffer_store_dwordx4 v[92:95], v3, s[16:19], s38 offen sc1
s_waitcnt lgkmcnt(0)
v_pk_fma_f32 v[64:65], v[28:29], v[20:21], v[32:33]
v_pk_fma_f32 v[66:67], v[30:31], v[20:21], v[34:35]
v_pk_fma_f32 v[68:69], v[28:29], v[22:23], v[32:33]
v_pk_fma_f32 v[70:71], v[30:31], v[22:23], v[34:35]
v_pk_fma_f32 v[72:73], v[28:29], v[24:25], v[32:33]
v_pk_fma_f32 v[74:75], v[30:31], v[24:25], v[34:35]
v_pk_fma_f32 v[76:77], v[28:29], v[26:27], v[32:33]
v_pk_fma_f32 v[78:79], v[30:31], v[26:27], v[34:35]
v_pk_fma_f32 v[196:197], v[196:197], v[12:13], v[64:65]
v_pk_fma_f32 v[198:199], v[198:199], v[12:13], v[66:67]
v_pk_fma_f32 v[200:201], v[200:201], v[14:15], v[68:69]
v_pk_fma_f32 v[202:203], v[202:203], v[14:15], v[70:71]
v_pk_fma_f32 v[204:205], v[204:205], v[16:17], v[72:73]
v_pk_fma_f32 v[206:207], v[206:207], v[16:17], v[74:75]
v_pk_fma_f32 v[208:209], v[208:209], v[18:19], v[76:77]
v_pk_fma_f32 v[210:211], v[210:211], v[18:19], v[78:79]
v_pk_mul_f32 v[48:49], v[196:197], v[196:197]
v_pk_mul_f32 v[50:51], v[198:199], v[198:199]
v_pk_mul_f32 v[52:53], v[200:201], v[200:201]
v_pk_mul_f32 v[54:55], v[202:203], v[202:203]
v_pk_mul_f32 v[56:57], v[204:205], v[204:205]
v_pk_mul_f32 v[58:59], v[206:207], v[206:207]
v_pk_mul_f32 v[60:61], v[208:209], v[208:209]
v_pk_mul_f32 v[62:63], v[210:211], v[210:211]
v_pk_fma_f32 v[48:49], v[48:49], v[44:45], v[46:47]
v_pk_fma_f32 v[50:51], v[50:51], v[44:45], v[46:47]
v_pk_fma_f32 v[52:53], v[52:53], v[44:45], v[46:47]
v_pk_fma_f32 v[54:55], v[54:55], v[44:45], v[46:47]
v_pk_fma_f32 v[56:57], v[56:57], v[44:45], v[46:47]
v_pk_fma_f32 v[58:59], v[58:59], v[44:45], v[46:47]
v_pk_fma_f32 v[60:61], v[60:61], v[44:45], v[46:47]
v_pk_fma_f32 v[62:63], v[62:63], v[44:45], v[46:47]
v_pk_mul_f32 v[48:49], v[48:49], v[196:197]
v_pk_mul_f32 v[50:51], v[50:51], v[198:199]
v_pk_mul_f32 v[52:53], v[52:53], v[200:201]
v_pk_mul_f32 v[54:55], v[54:55], v[202:203]
v_pk_mul_f32 v[56:57], v[56:57], v[204:205]
v_pk_mul_f32 v[58:59], v[58:59], v[206:207]
v_pk_mul_f32 v[60:61], v[60:61], v[208:209]
v_pk_mul_f32 v[62:63], v[62:63], v[210:211]
v_exp_f32 v48, v48
v_exp_f32 v49, v49
v_exp_f32 v50, v50
v_exp_f32 v51, v51
v_exp_f32 v52, v52
v_exp_f32 v53, v53
v_exp_f32 v54, v54
v_exp_f32 v55, v55
v_exp_f32 v56, v56
v_exp_f32 v57, v57
v_exp_f32 v58, v58
v_exp_f32 v59, v59
v_exp_f32 v60, v60
v_exp_f32 v61, v61
v_exp_f32 v62, v62
v_exp_f32 v63, v63
v_pk_add_f32 v[48:49], v[48:49], v[6:7]
v_pk_add_f32 v[50:51], v[50:51], v[6:7]
v_pk_add_f32 v[52:53], v[52:53], v[6:7]
v_pk_add_f32 v[54:55], v[54:55], v[6:7]
v_pk_add_f32 v[56:57], v[56:57], v[6:7]
v_pk_add_f32 v[58:59], v[58:59], v[6:7]
v_pk_add_f32 v[60:61], v[60:61], v[6:7]
v_pk_add_f32 v[62:63], v[62:63], v[6:7]
v_rcp_f32 v48, v48
v_rcp_f32 v49, v49
v_rcp_f32 v50, v50
v_rcp_f32 v51, v51
v_rcp_f32 v52, v52
v_rcp_f32 v53, v53
v_rcp_f32 v54, v54
v_rcp_f32 v55, v55
v_rcp_f32 v56, v56
v_rcp_f32 v57, v57
v_rcp_f32 v58, v58
v_rcp_f32 v59, v59
v_rcp_f32 v60, v60
v_rcp_f32 v61, v61
v_rcp_f32 v62, v62
v_rcp_f32 v63, v63
v_pk_mul_f32 v[196:197], v[196:197], v[48:49]
v_pk_mul_f32 v[198:199], v[198:199], v[50:51]
v_pk_mul_f32 v[200:201], v[200:201], v[52:53]
v_pk_mul_f32 v[202:203], v[202:203], v[54:55]
v_pk_mul_f32 v[204:205], v[204:205], v[56:57]
v_pk_mul_f32 v[206:207], v[206:207], v[58:59]
v_pk_mul_f32 v[208:209], v[208:209], v[60:61]
v_pk_mul_f32 v[210:211], v[210:211], v[62:63]
v_cvt_pk_bf16_f32 v80, v196, v197
v_cvt_pk_bf16_f32 v81, v198, v199
v_cvt_pk_bf16_f32 v82, v200, v201
v_cvt_pk_bf16_f32 v83, v202, v203
v_cvt_pk_bf16_f32 v84, v204, v205
v_cvt_pk_bf16_f32 v85, v206, v207
v_cvt_pk_bf16_f32 v86, v208, v209
v_cvt_pk_bf16_f32 v87, v210, v211
s_nop 0
v_permlane32_swap_b32 v80, v82
v_permlane32_swap_b32 v81, v83
v_permlane32_swap_b32 v84, v86
v_permlane32_swap_b32 v85, v87
s_add_u32 s38, s37, 6144
buffer_store_dwordx4 v[80:83], v3, s[16:19], s38 offen sc1
s_add_u32 s38, s37, 235520
buffer_store_dwordx4 v[84:87], v3, s[16:19], s38 offen sc1
s_waitcnt vmcnt(0)
s_branch FFN1_OOLEND
FFN1_DOVM:
s_waitcnt vmcnt(0)
s_branch FFN1_NOVM
FFN1_OOLEND:
s_barrier
s_mov_b32 s4, s76
s_mov_b32 s5, s77
s_mov_b32 s6, s84
s_mov_b32 s7, s85
s_mov_b32 s8, s78
s_mov_b32 s9, s79
s_mov_b32 s10, s80
s_mov_b32 s11, s81
s_and_b32 s40, s2, 7
s_lshr_b32 s41, s2, 3
s_and_b32 s86, s40, 1
s_bfe_u32 s12, s40, 0x10001
s_lshl_b32 s12, s12, 3
s_and_b32 s42, s41, 7
s_add_u32 s12, s12, s42
s_lshr_b32 s13, s40, 2
s_lshl_b32 s13, s13, 2
s_lshr_b32 s42, s41, 3
s_add_u32 s13, s13, s42
s_waitcnt lgkmcnt(0)
s_lshr_b32 s32, s3, 1
s_and_b32 s33, s3, 1
s_lshl_b32 s34, s32, 1
s_add_u32 s34, s34, s86
s_lshl_b32 s34, s34, 12
v_and_b32 v7, 15, v2
v_lshlrev_b32 v7, 4, v7
v_bfe_u32 v1, v2, 4, 1
v_lshl_add_u32 v7, v1, 9, v7
v_bfe_u32 v1, v2, 5, 1
v_lshl_add_u32 v7, v1, 10, v7
v_add_u32 v7, s34, v7
v_xor_b32 v8, 4096, v7
s_lshl_b32 s34, s33, 13
v_bfe_u32 v1, v2, 2, 2
v_lshlrev_b32 v9, 6, v1
v_and_b32 v1, 3, v2
v_lshl_add_u32 v9, v1, 3, v9
v_bfe_u32 v1, v2, 5, 1
v_lshl_add_u32 v9, v1, 11, v9
v_bfe_u32 v1, v2, 4, 1
v_lshl_add_u32 v9, v1, 9, v9
v_lshl_add_u32 v9, v1, 5, v9
v_add_u32 v9, s34, v9
v_xor_b32 v10, 32, v9
v_mov_b32 v3, v7
v_mov_b32 v4, v8
v_mov_b32 v5, v9
v_mov_b32 v6, v10
v_mov_b32 v84, 0
v_mov_b32 v85, 0
v_mov_b32 v86, 0
v_mov_b32 v87, 0
v_mov_b32 v88, 0
v_mov_b32 v89, 0
v_mov_b32 v90, 0
v_mov_b32 v91, 0
v_mov_b32 v100, 0
v_mov_b32 v101, 0
v_mov_b32 v102, 0
v_mov_b32 v103, 0
v_mov_b32 v104, 0
v_mov_b32 v105, 0
v_mov_b32 v106, 0
v_mov_b32 v107, 0
v_mov_b32 v116, 0
v_mov_b32 v117, 0
v_mov_b32 v118, 0
v_mov_b32 v119, 0
v_mov_b32 v120, 0
v_mov_b32 v121, 0
v_mov_b32 v122, 0
v_mov_b32 v123, 0
v_mov_b32 v132, 0
v_mov_b32 v133, 0
v_mov_b32 v134, 0
v_mov_b32 v135, 0
v_mov_b32 v136, 0
v_mov_b32 v137, 0
v_mov_b32 v138, 0
v_mov_b32 v139, 0
s_mov_b32 s28, s8
s_mov_b32 s29, s9
s_mov_b32 s30, 2048
s_mov_b32 s31, 0x20000
v_lshrrev_b32 v173, 4, v2
v_lshlrev_b32 v173, 3, v173
s_lshl_b32 s38, s13, 8
s_lshl_b32 s39, s33, 7
s_add_u32 s38, s38, s39
buffer_load_dwordx2 v[156:157], v173, s[28:31], s38 offen offset:0
buffer_load_dwordx2 v[158:159], v173, s[28:31], s38 offen offset:32
buffer_load_dwordx2 v[160:161], v173, s[28:31], s38 offen offset:64
buffer_load_dwordx2 v[162:163], v173, s[28:31], s38 offen offset:96
s_mov_b32 s14, 0
s_barrier
s_mov_b32 s24, s6
s_mov_b32 s25, s7
s_add_u32 s24, s24, 16777216
s_addc_u32 s25, s25, 0
s_mov_b32 s26, 4194304
s_mov_b32 s27, 0x20000
s_lshl_b32 s36, s12, 2
s_lshl_b32 s37, s32, 1
s_add_u32 s36, s36, s37
s_add_u32 s36, s36, s86
s_lshl_b32 s37, s36, 6
s_lshl_b32 s38, s13, 3
s_add_u32 s37, s37, s38
s_lshl_b32 s38, s33, 2
s_add_u32 s37, s37, s38
s_lshl_b32 s37, s37, 10
v_and_b32 v172, 15, v2
v_lshlrev_b32 v172, 4, v172
v_bfe_u32 v1, v2, 4, 1
v_lshl_add_u32 v172, v1, 9, v172
v_bfe_u32 v1, v2, 5, 1
v_lshl_add_u32 v172, v1, 8, v172
buffer_load_dwordx4 v[140:143], v172, s[24:27], s37 offen offset:0 sc1
buffer_load_dwordx4 v[144:147], v172, s[24:27], s37 offen offset:1024 sc1
buffer_load_dwordx4 v[148:151], v172, s[24:27], s37 offen offset:2048 sc1
buffer_load_dwordx4 v[152:155], v172, s[24:27], s37 offen offset:3072 sc1
s_mov_b32 s39, 0xffff0000
s_waitcnt vmcnt(0)
v_permlane32_swap_b32 v140, v142
v_permlane32_swap_b32 v141, v143
v_permlane32_swap_b32 v144, v146
v_permlane32_swap_b32 v145, v147
v_permlane32_swap_b32 v148, v150
v_permlane32_swap_b32 v149, v151
v_permlane32_swap_b32 v152, v154
v_permlane32_swap_b32 v153, v155
v_lshlrev_b32 v174, 16, v156
v_and_b32 v175, s39, v156
v_lshlrev_b32 v176, 16, v157
v_and_b32 v177, s39, v157
v_lshlrev_b32 v76, 16, v140
v_and_b32 v77, s39, v140
v_pk_add_f32 v[76:77], v[76:77], v[174:175]
v_lshlrev_b32 v78, 16, v141
v_and_b32 v79, s39, v141
v_pk_add_f32 v[78:79], v[78:79], v[176:177]
v_lshlrev_b32 v80, 16, v142
v_and_b32 v81, s39, v142
v_pk_add_f32 v[80:81], v[80:81], v[174:175]
v_lshlrev_b32 v82, 16, v143
v_and_b32 v83, s39, v143
v_pk_add_f32 v[82:83], v[82:83], v[176:177]
v_lshlrev_b32 v174, 16, v158
v_and_b32 v175, s39, v158
v_lshlrev_b32 v176, 16, v159
v_and_b32 v177, s39, v159
v_lshlrev_b32 v92, 16, v144
v_and_b32 v93, s39, v144
v_pk_add_f32 v[92:93], v[92:93], v[174:175]
v_lshlrev_b32 v94, 16, v145
v_and_b32 v95, s39, v145
v_pk_add_f32 v[94:95], v[94:95], v[176:177]
v_lshlrev_b32 v96, 16, v146
v_and_b32 v97, s39, v146
v_pk_add_f32 v[96:97], v[96:97], v[174:175]
v_lshlrev_b32 v98, 16, v147
v_and_b32 v99, s39, v147
v_pk_add_f32 v[98:99], v[98:99], v[176:177]
v_lshlrev_b32 v174, 16, v160
v_and_b32 v175, s39, v160
v_lshlrev_b32 v176, 16, v161
v_and_b32 v177, s39, v161
v_lshlrev_b32 v108, 16, v148
v_and_b32 v109, s39, v148
v_pk_add_f32 v[108:109], v[108:109], v[174:175]
v_lshlrev_b32 v110, 16, v149
v_and_b32 v111, s39, v149
v_pk_add_f32 v[110:111], v[110:111], v[176:177]
v_lshlrev_b32 v112, 16, v150
v_and_b32 v113, s39, v150
v_pk_add_f32 v[112:113], v[112:113], v[174:175]
v_lshlrev_b32 v114, 16, v151
v_and_b32 v115, s39, v151
v_pk_add_f32 v[114:115], v[114:115], v[176:177]
v_lshlrev_b32 v174, 16, v162
v_and_b32 v175, s39, v162
v_lshlrev_b32 v176, 16, v163
v_and_b32 v177, s39, v163
v_lshlrev_b32 v124, 16, v152
v_and_b32 v125, s39, v152
v_pk_add_f32 v[124:125], v[124:125], v[174:175]
v_lshlrev_b32 v126, 16, v153
v_and_b32 v127, s39, v153
v_pk_add_f32 v[126:127], v[126:127], v[176:177]
v_lshlrev_b32 v128, 16, v154
v_and_b32 v129, s39, v154
v_pk_add_f32 v[128:129], v[128:129], v[174:175]
v_lshlrev_b32 v130, 16, v155
v_and_b32 v131, s39, v155
v_pk_add_f32 v[130:131], v[130:131], v[176:177]
s_barrier
s_setprio 1
s_mov_b32 s24, s6
s_mov_b32 s25, s7
s_add_u32 s24, s24, 58720256
s_addc_u32 s25, s25, 0
s_mov_b32 s26, 8388608
s_mov_b32 s27, 0x20000
s_lshl_b32 s37, s12, 3
s_add_u32 s37, s37, s13
s_lshl_b32 s37, s37, 1
s_add_u32 s38, s37, s86
s_lshl_b32 s38, s38, 2
s_add_u32 s38, s38, s3
s_lshl_b32 s38, s38, 13
s_xor_b32 s39, s86, 1
s_add_u32 s39, s39, s37
s_lshl_b32 s39, s39, 2
s_add_u32 s39, s39, s3
s_lshl_b32 s39, s39, 13
v_lshlrev_b32 v172, 4, v2
ds_read_b128 v[12:15], v3 offset:0
ds_read_b64_tr_b16 v[44:45], v5 offset:16384
ds_read_b64_tr_b16 v[46:47], v5 offset:17408
ds_read_b128 v[16:19], v3 offset:256
ds_read_b128 v[20:23], v4 offset:0
ds_read_b128 v[24:27], v4 offset:256
ds_read_b64_tr_b16 v[48:49], v6 offset:16384
ds_read_b64_tr_b16 v[50:51], v6 offset:17408
ds_read_b64_tr_b16 v[52:53], v5 offset:16640
ds_read_b64_tr_b16 v[54:55], v5 offset:17664
ds_read_b64_tr_b16 v[56:57], v6 offset:16640
ds_read_b64_tr_b16 v[58:59], v6 offset:17664
s_mov_b32 s15, 22
.p2align 4
FFN2_CLOOP:
s_waitcnt lgkmcnt(6)
v_mfma_f32_16x16x32_bf16 v[76:79], v[44:47], v[12:15], v[76:79]
ds_read_b128 v[28:31], v3 offset:2048
ds_read_b64_tr_b16 v[60:61], v5 offset:20480
v_mfma_f32_16x16x32_bf16 v[80:83], v[44:47], v[16:19], v[80:83]
ds_read_b64_tr_b16 v[62:63], v5 offset:21504
v_mfma_f32_16x16x32_bf16 v[84:87], v[44:47], v[20:23], v[84:87]
ds_read_b128 v[32:35], v3 offset:2304
v_mfma_f32_16x16x32_bf16 v[88:91], v[44:47], v[24:27], v[88:91]
ds_read_b128 v[36:39], v4 offset:2048
s_waitcnt lgkmcnt(9)
v_mfma_f32_16x16x32_bf16 v[92:95], v[48:51], v[12:15], v[92:95]
ds_read_b128 v[40:43], v4 offset:2304
v_mfma_f32_16x16x32_bf16 v[96:99], v[48:51], v[16:19], v[96:99]
ds_read_b64_tr_b16 v[64:65], v6 offset:20480
v_mfma_f32_16x16x32_bf16 v[100:103], v[48:51], v[20:23], v[100:103]
ds_read_b64_tr_b16 v[66:67], v6 offset:21504
v_mfma_f32_16x16x32_bf16 v[104:107], v[48:51], v[24:27], v[104:107]
ds_read_b64_tr_b16 v[68:69], v5 offset:20736
s_waitcnt lgkmcnt(11)
v_mfma_f32_16x16x32_bf16 v[108:111], v[52:55], v[12:15], v[108:111]
ds_read_b64_tr_b16 v[70:71], v5 offset:21760
v_mfma_f32_16x16x32_bf16 v[112:115], v[52:55], v[16:19], v[112:115]
ds_read_b64_tr_b16 v[72:73], v6 offset:20736
v_mfma_f32_16x16x32_bf16 v[116:119], v[52:55], v[20:23], v[116:119]
ds_read_b64_tr_b16 v[74:75], v6 offset:21760
s_add_u32 s14, s14, 32768
s_cmp_eq_u32 s14, 131072
v_mfma_f32_16x16x32_bf16 v[120:123], v[52:55], v[24:27], v[120:123]
s_cselect_b32 s14, 0, s14
s_waitcnt lgkmcnt(12)
v_mfma_f32_16x16x32_bf16 v[124:127], v[56:59], v[12:15], v[124:127]
v_add_u32 v3, s14, v7
v_mfma_f32_16x16x32_bf16 v[128:131], v[56:59], v[16:19], v[128:131]
v_add_u32 v4, s14, v8
v_mfma_f32_16x16x32_bf16 v[132:135], v[56:59], v[20:23], v[132:135]
v_add_u32 v5, s14, v9
v_mfma_f32_16x16x32_bf16 v[136:139], v[56:59], v[24:27], v[136:139]
v_add_u32 v6, s14, v10
s_waitcnt lgkmcnt(6)
v_mfma_f32_16x16x32_bf16 v[76:79], v[60:63], v[28:31], v[76:79]
v_mfma_f32_16x16x32_bf16 v[80:83], v[60:63], v[32:35], v[80:83]
v_mfma_f32_16x16x32_bf16 v[84:87], v[60:63], v[36:39], v[84:87]
s_waitcnt lgkmcnt(0)
s_barrier
ds_read_b128 v[12:15], v3 offset:0
ds_read_b64_tr_b16 v[44:45], v5 offset:16384
v_mfma_f32_16x16x32_bf16 v[88:91], v[60:63], v[40:43], v[88:91]
ds_read_b64_tr_b16 v[46:47], v5 offset:17408
v_mfma_f32_16x16x32_bf16 v[92:95], v[64:67], v[28:31], v[92:95]
ds_read_b128 v[16:19], v3 offset:256
v_mfma_f32_16x16x32_bf16 v[96:99], v[64:67], v[32:35], v[96:99]
ds_read_b128 v[20:23], v4 offset:0
v_mfma_f32_16x16x32_bf16 v[100:103], v[64:67], v[36:39], v[100:103]
ds_read_b128 v[24:27], v4 offset:256
v_mfma_f32_16x16x32_bf16 v[104:107], v[64:67], v[40:43], v[104:107]
ds_read_b64_tr_b16 v[48:49], v6 offset:16384
v_mfma_f32_16x16x32_bf16 v[108:111], v[68:71], v[28:31], v[108:111]
ds_read_b64_tr_b16 v[50:51], v6 offset:17408
v_mfma_f32_16x16x32_bf16 v[112:115], v[68:71], v[32:35], v[112:115]
ds_read_b64_tr_b16 v[52:53], v5 offset:16640
v_mfma_f32_16x16x32_bf16 v[116:119], v[68:71], v[36:39], v[116:119]
ds_read_b64_tr_b16 v[54:55], v5 offset:17664
v_mfma_f32_16x16x32_bf16 v[120:123], v[68:71], v[40:43], v[120:123]
ds_read_b64_tr_b16 v[56:57], v6 offset:16640
v_mfma_f32_16x16x32_bf16 v[124:127], v[72:75], v[28:31], v[124:127]
ds_read_b64_tr_b16 v[58:59], v6 offset:17664
v_mfma_f32_16x16x32_bf16 v[128:131], v[72:75], v[32:35], v[128:131]
v_mfma_f32_16x16x32_bf16 v[132:135], v[72:75], v[36:39], v[132:135]
s_sub_u32 s15, s15, 1
s_cmp_lg_u32 s15, 0
v_mfma_f32_16x16x32_bf16 v[136:139], v[72:75], v[40:43], v[136:139]
s_cbranch_scc1 FFN2_CLOOP
s_waitcnt lgkmcnt(0)
s_nop 7
buffer_store_dwordx4 v[84:87], v172, s[24:27], s38 offen offset:0 sc1
buffer_store_dwordx4 v[88:91], v172, s[24:27], s38 offen offset:1024 sc1
buffer_store_dwordx4 v[100:103], v172, s[24:27], s38 offen offset:2048 sc1
buffer_store_dwordx4 v[104:107], v172, s[24:27], s38 offen offset:3072 sc1
s_add_u32 s38, s38, 4096
buffer_store_dwordx4 v[116:119], v172, s[24:27], s38 offen offset:0 sc1
buffer_store_dwordx4 v[120:123], v172, s[24:27], s38 offen offset:1024 sc1
buffer_store_dwordx4 v[132:135], v172, s[24:27], s38 offen offset:2048 sc1
buffer_store_dwordx4 v[136:139], v172, s[24:27], s38 offen offset:3072 sc1
s_mov_b32 s15, 12
.p2align 4
FFN2_CTLOOP:
s_waitcnt lgkmcnt(6)
v_mfma_f32_16x16x32_bf16 v[76:79], v[44:47], v[12:15], v[76:79]
ds_read_b128 v[28:31], v3 offset:2048
ds_read_b64_tr_b16 v[60:61], v5 offset:20480
v_mfma_f32_16x16x32_bf16 v[80:83], v[44:47], v[16:19], v[80:83]
ds_read_b64_tr_b16 v[62:63], v5 offset:21504
ds_read_b128 v[32:35], v3 offset:2304
s_waitcnt lgkmcnt(8)
v_mfma_f32_16x16x32_bf16 v[92:95], v[48:51], v[12:15], v[92:95]
ds_read_b64_tr_b16 v[64:65], v6 offset:20480
v_mfma_f32_16x16x32_bf16 v[96:99], v[48:51], v[16:19], v[96:99]
ds_read_b64_tr_b16 v[66:67], v6 offset:21504
ds_read_b64_tr_b16 v[68:69], v5 offset:20736
s_waitcnt lgkmcnt(9)
v_mfma_f32_16x16x32_bf16 v[108:111], v[52:55], v[12:15], v[108:111]
ds_read_b64_tr_b16 v[70:71], v5 offset:21760
ds_read_b64_tr_b16 v[72:73], v6 offset:20736
v_mfma_f32_16x16x32_bf16 v[112:115], v[52:55], v[16:19], v[112:115]
ds_read_b64_tr_b16 v[74:75], v6 offset:21760
s_add_u32 s14, s14, 32768
s_cmp_eq_u32 s14, 131072
s_cselect_b32 s14, 0, s14
s_waitcnt lgkmcnt(10)
v_mfma_f32_16x16x32_bf16 v[124:127], v[56:59], v[12:15], v[124:127]
v_add_u32 v3, s14, v7
v_add_u32 v4, s14, v8
v_mfma_f32_16x16x32_bf16 v[128:131], v[56:59], v[16:19], v[128:131]
v_add_u32 v5, s14, v9
v_add_u32 v6, s14, v10
s_waitcnt lgkmcnt(6)
v_mfma_f32_16x16x32_bf16 v[76:79], v[60:63], v[28:31], v[76:79]
v_mfma_f32_16x16x32_bf16 v[80:83], v[60:63], v[32:35], v[80:83]
s_waitcnt lgkmcnt(0)
s_cmp_eq_u32 s15, 9
s_cbranch_scc1 FFN2_DD
FFN2_ND:
s_barrier
s_cmp_eq_u32 s15, 3
s_cbranch_scc1 FFN2_DL
FFN2_NL:
ds_read_b128 v[12:15], v3 offset:0
ds_read_b64_tr_b16 v[44:45], v5 offset:16384
v_mfma_f32_16x16x32_bf16 v[92:95], v[64:67], v[28:31], v[92:95]
ds_read_b64_tr_b16 v[46:47], v5 offset:17408
ds_read_b128 v[16:19], v3 offset:256
v_mfma_f32_16x16x32_bf16 v[96:99], v[64:67], v[32:35], v[96:99]
ds_read_b64_tr_b16 v[48:49], v6 offset:16384
v_mfma_f32_16x16x32_bf16 v[108:111], v[68:71], v[28:31], v[108:111]
ds_read_b64_tr_b16 v[50:51], v6 offset:17408
ds_read_b64_tr_b16 v[52:53], v5 offset:16640
v_mfma_f32_16x16x32_bf16 v[112:115], v[68:71], v[32:35], v[112:115]
ds_read_b64_tr_b16 v[54:55], v5 offset:17664
ds_read_b64_tr_b16 v[56:57], v6 offset:16640
v_mfma_f32_16x16x32_bf16 v[124:127], v[72:75], v[28:31], v[124:127]
ds_read_b64_tr_b16 v[58:59], v6 offset:17664
s_sub_u32 s15, s15, 1
s_cmp_lg_u32 s15, 0
v_mfma_f32_16x16x32_bf16 v[128:131], v[72:75], v[32:35], v[128:131]
s_cbranch_scc1 FFN2_CTLOOP
s_waitcnt lgkmcnt(0)
s_setprio 0
s_nop 7
s_mov_b32 s16, s10
s_mov_b32 s17, s11
s_mov_b32 s18, 4194304
s_mov_b32 s19, 0x20000
v_and_b32 v173, 31, v2
v_lshlrev_b32 v173, 11, v173
v_bfe_u32 v1, v2, 5, 1
v_lshl_add_u32 v173, v1, 4, v173
s_lshl_b32 s37, s36, 16
s_lshl_b32 s38, s13, 8
s_add_u32 s37, s37, s38
s_lshl_b32 s38, s33, 7
s_add_u32 s37, s37, s38
s_waitcnt vmcnt(0)
v_pk_add_f32 v[76:77], v[76:77], v[140:141]
v_pk_add_f32 v[78:79], v[78:79], v[142:143]
v_pk_add_f32 v[80:81], v[80:81], v[144:145]
v_pk_add_f32 v[82:83], v[82:83], v[146:147]
v_cvt_pk_bf16_f32 v176, v76, v77
v_cvt_pk_bf16_f32 v177, v78, v79
v_cvt_pk_bf16_f32 v178, v80, v81
v_cvt_pk_bf16_f32 v179, v82, v83
s_nop 1
v_permlane16_swap_b32 v176, v178
v_permlane16_swap_b32 v177, v179
buffer_store_dwordx4 v[176:179], v173, s[16:19], s37 offen offset:0
v_pk_add_f32 v[92:93], v[92:93], v[148:149]
v_pk_add_f32 v[94:95], v[94:95], v[150:151]
v_pk_add_f32 v[96:97], v[96:97], v[152:153]
v_pk_add_f32 v[98:99], v[98:99], v[154:155]
v_cvt_pk_bf16_f32 v180, v92, v93
v_cvt_pk_bf16_f32 v181, v94, v95
v_cvt_pk_bf16_f32 v182, v96, v97
v_cvt_pk_bf16_f32 v183, v98, v99
s_nop 1
v_permlane16_swap_b32 v180, v182
v_permlane16_swap_b32 v181, v183
buffer_store_dwordx4 v[180:183], v173, s[16:19], s37 offen offset:32
v_pk_add_f32 v[108:109], v[108:109], v[156:157]
v_pk_add_f32 v[110:111], v[110:111], v[158:159]
v_pk_add_f32 v[112:113], v[112:113], v[160:161]
v_pk_add_f32 v[114:115], v[114:115], v[162:163]
v_cvt_pk_bf16_f32 v184, v108, v109
v_cvt_pk_bf16_f32 v185, v110, v111
v_cvt_pk_bf16_f32 v186, v112, v113
v_cvt_pk_bf16_f32 v187, v114, v115
s_nop 1
v_permlane16_swap_b32 v184, v186
v_permlane16_swap_b32 v185, v187
buffer_store_dwordx4 v[184:187], v173, s[16:19], s37 offen offset:64
v_pk_add_f32 v[124:125], v[124:125], v[164:165]
v_pk_add_f32 v[126:127], v[126:127], v[166:167]
v_pk_add_f32 v[128:129], v[128:129], v[168:169]
v_pk_add_f32 v[130:131], v[130:131], v[170:171]
v_cvt_pk_bf16_f32 v188, v124, v125
v_cvt_pk_bf16_f32 v189, v126, v127
v_cvt_pk_bf16_f32 v190, v128, v129
v_cvt_pk_bf16_f32 v191, v130, v131
s_nop 1
v_permlane16_swap_b32 v188, v190
v_permlane16_swap_b32 v189, v191
buffer_store_dwordx4 v[188:191], v173, s[16:19], s37 offen offset:96
s_waitcnt vmcnt(0)
s_branch FFN2_OOLEND
FFN2_DD:
s_waitcnt vmcnt(0)
s_branch FFN2_ND
FFN2_DL:
buffer_load_dwordx4 v[140:143], v172, s[24:27], s39 offen offset:0 sc1
buffer_load_dwordx4 v[144:147], v172, s[24:27], s39 offen offset:1024 sc1
buffer_load_dwordx4 v[148:151], v172, s[24:27], s39 offen offset:2048 sc1
buffer_load_dwordx4 v[152:155], v172, s[24:27], s39 offen offset:3072 sc1
s_add_u32 s39, s39, 4096
buffer_load_dwordx4 v[156:159], v172, s[24:27], s39 offen offset:0 sc1
buffer_load_dwordx4 v[160:163], v172, s[24:27], s39 offen offset:1024 sc1
buffer_load_dwordx4 v[164:167], v172, s[24:27], s39 offen offset:2048 sc1
buffer_load_dwordx4 v[168:171], v172, s[24:27], s39 offen offset:3072 sc1
s_branch FFN2_NL
FFN2_OOLEND:
s_branch MEGA_END
MEGA_ATTP:
s_mov_b32 s4, s84
s_mov_b32 s5, s85
s_and_b32 s6, s2, 7
s_lshr_b32 s7, s2, 3
s_lshl_b32 s8, s6, 2
s_lshr_b32 s9, s7, 3
s_add_u32 s8, s8, s9
s_and_b32 s24, s7, 7
s_mov_b32 s88, s24
s_mov_b32 s89, s8
v_lshlrev_b32 v3, 4, v2
s_lshl_b32 s10, s8, 17
s_mov_b32 s32, s68
s_mov_b32 s33, s69
s_mov_b32 s34, s76
s_mov_b32 s35, s77
s_mov_b32 s44, s72
s_mov_b32 s45, s73
s_mov_b32 s12, s4
s_mov_b32 s13, s5
s_add_u32 s12, s12, 4194304
s_addc_u32 s13, s13, 0
s_add_u32 s12, s12, s10
s_addc_u32 s13, s13, 0
s_mov_b32 s14, 131072
s_mov_b32 s15, 0x20000
s_mov_b32 s16, s4
s_mov_b32 s17, s5
s_add_u32 s16, s16, 8388608
s_addc_u32 s17, s17, 0
s_add_u32 s16, s16, s10
s_addc_u32 s17, s17, 0
s_mov_b32 s18, 131072
s_mov_b32 s19, 0x20000
s_sub_u32 s9, s3, 4
s_lshl_b32 s20, s9, 11
s_lshl_b32 s22, s9, 11
s_mov_b32 s21, 0
s_add_u32 m0, s20, s21
s_nop 0
buffer_load_dwordx4 v3, s[12:15], s22 offen sc1 lds
buffer_load_dwordx4 v3, s[12:15], s22 offen offset:1024 sc1 lds
s_add_u32 m0, m0, 8192
s_add_u32 s21, s21, 16384
buffer_load_dwordx4 v3, s[16:19], s22 offen sc1 lds
buffer_load_dwordx4 v3, s[16:19], s22 offen offset:1024 sc1 lds
s_and_b32 s21, s21, 131071
s_add_u32 s22, s22, 8192
s_add_u32 m0, s20, s21
s_nop 0
buffer_load_dwordx4 v3, s[12:15], s22 offen sc1 lds
buffer_load_dwordx4 v3, s[12:15], s22 offen offset:1024 sc1 lds
s_add_u32 m0, m0, 8192
s_add_u32 s21, s21, 16384
buffer_load_dwordx4 v3, s[16:19], s22 offen sc1 lds
buffer_load_dwordx4 v3, s[16:19], s22 offen offset:1024 sc1 lds
s_and_b32 s21, s21, 131071
s_add_u32 s22, s22, 8192
s_mov_b32 s36, s44
s_mov_b32 s37, s45
s_mov_b32 s38, 7340032
s_mov_b32 s39, 0x20000
s_mov_b32 s48, s34
s_mov_b32 s49, s35
s_mov_b32 s50, 7340032
s_mov_b32 s51, 0x20000
s_mov_b32 s52, s32
s_mov_b32 s53, s33
s_mov_b32 s54, 2097152
s_mov_b32 s55, 0x20000
s_lshl_b32 s40, s9, 6
v_add_u32 v129, s40, v2
v_min_u32 v129, 223, v129
v_lshlrev_b32 v129, 7, v129
v_lshrrev_b32 v130, 3, v2
v_lshlrev_b32 v130, 11, v130
v_and_b32 v131, 7, v2
v_lshl_add_u32 v130, v131, 7, v130
s_lshr_b32 s41, s2, 3
s_lshl_b32 s41, s41, 2
s_add_u32 s41, s41, s9
s_lshl_b32 s41, s41, 14
s_bfe_u32 s40, s2, 0x10002
s_lshl_b32 s40, s40, 10
s_add_u32 s41, s41, s40
s_mul_i32 s40, s2, 28672
s_waitcnt vmcnt(4)
s_barrier
s_add_u32 m0, s20, s21
s_nop 0
buffer_load_dwordx4 v3, s[12:15], s22 offen sc1 lds
buffer_load_dwordx4 v3, s[12:15], s22 offen offset:1024 sc1 lds
s_add_u32 m0, m0, 8192
s_add_u32 s21, s21, 16384
buffer_load_dwordx4 v3, s[16:19], s22 offen sc1 lds
buffer_load_dwordx4 v3, s[16:19], s22 offen offset:1024 sc1 lds
s_and_b32 s21, s21, 131071
s_add_u32 s22, s22, 8192
s_add_u32 m0, s20, s21
s_nop 0
buffer_load_dwordx4 v3, s[12:15], s22 offen sc1 lds
buffer_load_dwordx4 v3, s[12:15], s22 offen offset:1024 sc1 lds
s_add_u32 m0, m0, 8192
s_add_u32 s21, s21, 16384
buffer_load_dwordx4 v3, s[16:19], s22 offen sc1 lds
buffer_load_dwordx4 v3, s[16:19], s22 offen offset:1024 sc1 lds
s_and_b32 s21, s21, 131071
s_add_u32 s22, s22, 8192
s_add_u32 m0, s20, s21
s_nop 0
buffer_load_dwordx4 v3, s[12:15], s22 offen sc1 lds
buffer_load_dwordx4 v3, s[12:15], s22 offen offset:1024 sc1 lds
s_add_u32 m0, m0, 8192
s_add_u32 s21, s21, 16384
buffer_load_dwordx4 v3, s[16:19], s22 offen sc1 lds
buffer_load_dwordx4 v3, s[16:19], s22 offen offset:1024 sc1 lds
s_and_b32 s21, s21, 131071
s_add_u32 s22, s22, 8192
s_add_u32 m0, s20, s21
s_nop 0
buffer_load_dwordx4 v3, s[12:15], s22 offen sc1 lds
buffer_load_dwordx4 v3, s[12:15], s22 offen offset:1024 sc1 lds
s_add_u32 m0, m0, 8192
s_add_u32 s21, s21, 16384
buffer_load_dwordx4 v3, s[16:19], s22 offen sc1 lds
buffer_load_dwordx4 v3, s[16:19], s22 offen offset:1024 sc1 lds
s_and_b32 s21, s21, 131071
s_add_u32 s22, s22, 8192
s_add_u32 m0, s20, s21
s_nop 0
buffer_load_dwordx4 v3, s[12:15], s22 offen sc1 lds
buffer_load_dwordx4 v3, s[12:15], s22 offen offset:1024 sc1 lds
s_add_u32 m0, m0, 8192
s_add_u32 s21, s21, 16384
buffer_load_dwordx4 v3, s[16:19], s22 offen sc1 lds
buffer_load_dwordx4 v3, s[16:19], s22 offen offset:1024 sc1 lds
s_and_b32 s21, s21, 131071
s_add_u32 s22, s22, 8192
s_mov_b32 s28, 0
ATP_LOOP:
s_waitcnt vmcnt(20)
s_barrier
s_add_u32 m0, s20, s21
s_nop 0
buffer_load_dwordx4 v3, s[12:15], s22 offen sc1 lds
buffer_load_dwordx4 v3, s[12:15], s22 offen offset:1024 sc1 lds
s_add_u32 m0, m0, 8192
s_add_u32 s21, s21, 16384
buffer_load_dwordx4 v3, s[16:19], s22 offen sc1 lds
buffer_load_dwordx4 v3, s[16:19], s22 offen offset:1024 sc1 lds
s_and_b32 s21, s21, 131071
s_add_u32 s22, s22, 8192
s_sub_u32 s29, s28, s9
s_cmp_lg_u32 s29, 1
s_cbranch_scc1 ATP_N1
buffer_load_dword v128, v129, s[36:39], s40 offen
ATP_N1:
s_cmp_lg_u32 s29, 5
s_cbranch_scc1 ATP_N2
buffer_load_dword v128, v129, s[48:51], s40 offen
ATP_N2:
s_cmp_lg_u32 s29, 9
s_cbranch_scc1 ATP_N3
buffer_load_dword v128, v130, s[52:55], s41 offen
ATP_N3:
s_add_u32 s28, s28, 1
s_cmp_lt_u32 s28, 16
s_cbranch_scc1 ATP_LOOP
s_waitcnt vmcnt(0)
s_waitcnt lgkmcnt(0)
s_barrier
v_mov_b32 v7, 131072
ds_read_b32 v6, v7
s_waitcnt lgkmcnt(0)
v_readfirstlane_b32 s30, v6
s_nop 1
s_cmp_eq_u32 s30, 0
s_cbranch_scc1 ATP_FIN
s_lshl_b32 s22, s9, 11
s_mov_b32 s28, 16
ATP_SLOW:
s_mov_b32 s21, 0
s_add_u32 m0, s20, s21
s_nop 0
buffer_load_dwordx4 v3, s[12:15], s22 offen sc1 lds
buffer_load_dwordx4 v3, s[12:15], s22 offen offset:1024 sc1 lds
s_add_u32 m0, m0, 8192
s_add_u32 s21, s21, 16384
buffer_load_dwordx4 v3, s[16:19], s22 offen sc1 lds
buffer_load_dwordx4 v3, s[16:19], s22 offen offset:1024 sc1 lds
s_and_b32 s21, s21, 131071
s_add_u32 s22, s22, 8192
s_waitcnt vmcnt(0)
s_barrier
s_barrier
s_sub_u32 s28, s28, 1
s_cmp_lg_u32 s28, 0
s_cbranch_scc1 ATP_SLOW
ATP_FIN:
s_mov_b32 s4, s68
s_mov_b32 s5, s69
s_mov_b32 s6, s84
s_mov_b32 s7, s85
s_mov_b32 s8, s64
s_mov_b32 s9, s65
s_and_b32 s40, s2, 7
s_lshr_b32 s41, s2, 3
s_and_b32 s12, s40, 3
s_lshl_b32 s12, s12, 2
s_and_b32 s42, s41, 3
s_add_u32 s12, s12, s42
s_lshr_b32 s13, s40, 2
s_lshl_b32 s13, s13, 3
s_lshr_b32 s42, s41, 2
s_add_u32 s13, s13, s42
s_waitcnt lgkmcnt(0)
s_sub_u32 s44, s3, 4
s_mov_b32 s16, s6
s_mov_b32 s17, s7
s_add_u32 s16, s16, 12582912
s_addc_u32 s17, s17, 0
s_mov_b32 s18, 4194304
s_mov_b32 s19, 0x20000
v_lshlrev_b32 v229, 4, v2
s_lshl_b32 s32, s12, 2
s_add_u32 s32, s32, s44
s_mul_i32 s32, s32, 65536
s_mov_b32 s20, s4
s_mov_b32 s21, s5
s_mov_b32 s22, 2097152
s_mov_b32 s23, 0x20000
s_lshl_b32 s33, s44, 12
v_bfe_u32 v240, v2, 2, 2
v_and_b32 v241, 3, v2
v_lshrrev_b32 v242, 4, v2
s_mov_b32 s34, 2048
v_lshrrev_b32 v243, 1, v242
v_lshl_add_u32 v240, v243, 2, v240
v_and_b32 v242, 1, v242
v_mul_lo_u32 v240, v240, s34
v_lshl_add_u32 v240, v241, 4, v240
v_lshl_add_u32 v240, v242, 6, v240
s_mul_i32 s35, s44, 32768
s_lshl_b32 s36, s13, 7
v_and_b32 v241, 32, v2
v_xor_b32 v240, v240, v241
s_add_u32 s40, s35, s36
v_add_u32 v230, s40, v240
s_add_u32 s40, s35, s36
s_add_u32 s40, s40, 16384
v_add_u32 v231, s40, v240
s_lshl_b32 s41, s44, 11
s_add_u32 s41, s41, 16384
s_mov_b32 s42, 0
s_barrier
s_cmp_lg_u32 s3, 4
s_cbranch_scc1 F2S_NW4
s_mov_b32 s48, s6
s_mov_b32 s49, s7
s_add_u32 s48, s48, 50331648
s_addc_u32 s49, s49, 0
s_mov_b32 s50, 262144
s_mov_b32 s51, 0x20000
s_lshl_b32 s46, s88, 5
s_add_u32 s46, s46, s89
s_add_u32 s46, s46, 512
s_lshl_b32 s46, s46, 7
s_add_u32 s47, s90, 2
v_mov_b32 v250, s47
v_mov_b32 v251, 0
s_mov_b64 exec, 1
buffer_store_dword v250, v251, s[48:51], s46 offen sc1
s_mov_b64 exec, -1
F2S_NW4:
s_add_u32 m0, s41, 0
s_nop 0
buffer_load_dwordx4 v230, s[20:23], s42 offen lds
s_add_u32 m0, s41, 1024
s_nop 0
buffer_load_dwordx4 v231, s[20:23], s42 offen lds
s_add_u32 s42, s42, 131072
s_add_u32 m0, s41, 24576
s_nop 0
buffer_load_dwordx4 v230, s[20:23], s42 offen lds
s_add_u32 m0, s41, 25600
s_nop 0
buffer_load_dwordx4 v231, s[20:23], s42 offen lds
s_add_u32 s42, s42, 131072
s_add_u32 m0, s41, 49152
s_nop 0
buffer_load_dwordx4 v230, s[20:23], s42 offen lds
s_add_u32 m0, s41, 50176
s_nop 0
buffer_load_dwordx4 v231, s[20:23], s42 offen lds
s_add_u32 s42, s42, 131072
s_add_u32 m0, s41, 73728
s_nop 0
buffer_load_dwordx4 v230, s[20:23], s42 offen lds
s_add_u32 m0, s41, 74752
s_nop 0
buffer_load_dwordx4 v231, s[20:23], s42 offen lds
s_add_u32 s42, s42, 131072
s_add_u32 m0, s41, 98304
s_nop 0
buffer_load_dwordx4 v230, s[20:23], s42 offen lds
s_add_u32 m0, s41, 99328
s_nop 0
buffer_load_dwordx4 v231, s[20:23], s42 offen lds
s_add_u32 s42, s42, 131072
s_cmp_lg_u32 s3, 4
s_cbranch_scc1 F2P_NW4
s_mov_b32 s48, s6
s_mov_b32 s49, s7
s_add_u32 s48, s48, 50331648
s_addc_u32 s49, s49, 0
s_mov_b32 s50, 262144
s_mov_b32 s51, 0x20000
s_lshr_b32 s46, s12, 1
s_lshl_b32 s46, s46, 5
s_add_u32 s46, s46, 512
s_lshl_b32 s46, s46, 7
v_min_u32 v251, 31, v2
v_mul_u32_u24 v251, 128, v251
s_add_u32 s47, s90, 2
s_mov_b32 s45, 0
F2_POLL:
buffer_load_dword v250, v251, s[48:51], s46 offen sc1
s_waitcnt vmcnt(0)
v_cmp_ne_u32 vcc, s47, v250
s_add_u32 s45, s45, 1
s_cmp_gt_u32 s45, 400000
s_cbranch_scc1 F2_POK
s_cbranch_vccnz F2_POLL
F2_POK:
F2P_NW4:
s_barrier
s_add_u32 m0, s33, 0
s_nop 0
buffer_load_dwordx4 v229, s[16:19], s32 offen offset:0 sc1 lds
buffer_load_dwordx4 v229, s[16:19], s32 offen offset:1024 sc1 lds
buffer_load_dwordx4 v229, s[16:19], s32 offen offset:2048 sc1 lds
buffer_load_dwordx4 v229, s[16:19], s32 offen offset:3072 sc1 lds
s_add_u32 s32, s32, 4096
s_add_u32 m0, s33, 24576
s_nop 0
buffer_load_dwordx4 v229, s[16:19], s32 offen offset:0 sc1 lds
buffer_load_dwordx4 v229, s[16:19], s32 offen offset:1024 sc1 lds
buffer_load_dwordx4 v229, s[16:19], s32 offen offset:2048 sc1 lds
buffer_load_dwordx4 v229, s[16:19], s32 offen offset:3072 sc1 lds
s_add_u32 s32, s32, 4096
s_add_u32 m0, s33, 49152
s_nop 0
buffer_load_dwordx4 v229, s[16:19], s32 offen offset:0 sc1 lds
buffer_load_dwordx4 v229, s[16:19], s32 offen offset:1024 sc1 lds
buffer_load_dwordx4 v229, s[16:19], s32 offen offset:2048 sc1 lds
buffer_load_dwordx4 v229, s[16:19], s32 offen offset:3072 sc1 lds
s_add_u32 s32, s32, 4096
s_waitcnt vmcnt(8)
s_mov_b32 s14, 0
s_barrier
s_add_u32 m0, s33, 73728
s_nop 0
buffer_load_dwordx4 v229, s[16:19], s32 offen offset:0 sc1 lds
buffer_load_dwordx4 v229, s[16:19], s32 offen offset:1024 sc1 lds
buffer_load_dwordx4 v229, s[16:19], s32 offen offset:2048 sc1 lds
buffer_load_dwordx4 v229, s[16:19], s32 offen offset:3072 sc1 lds
s_add_u32 s32, s32, 4096
s_add_u32 m0, s33, 98304
s_nop 0
buffer_load_dwordx4 v229, s[16:19], s32 offen offset:0 sc1 lds
buffer_load_dwordx4 v229, s[16:19], s32 offen offset:1024 sc1 lds
buffer_load_dwordx4 v229, s[16:19], s32 offen offset:2048 sc1 lds
buffer_load_dwordx4 v229, s[16:19], s32 offen offset:3072 sc1 lds
s_add_u32 s32, s32, 4096
s_waitcnt vmcnt(12)
s_barrier
s_add_u32 s45, s14, s33
s_add_u32 s43, s14, s41
s_add_u32 m0, s45, 0
s_nop 0
buffer_load_dwordx4 v229, s[16:19], s32 offen offset:0 sc1 lds
buffer_load_dwordx4 v229, s[16:19], s32 offen offset:1024 sc1 lds
buffer_load_dwordx4 v229, s[16:19], s32 offen offset:2048 sc1 lds
buffer_load_dwordx4 v229, s[16:19], s32 offen offset:3072 sc1 lds
s_add_u32 s32, s32, 4096
s_add_u32 m0, s43, 0
s_nop 0
buffer_load_dwordx4 v230, s[20:23], s42 offen lds
s_add_u32 m0, s43, 1024
s_nop 0
buffer_load_dwordx4 v231, s[20:23], s42 offen lds
s_add_u32 s42, s42, 131072
s_add_u32 s14, s14, 24576
s_cmp_eq_u32 s14, 122880
s_cselect_b32 s14, 0, s14
s_waitcnt vmcnt(14)
s_barrier
s_add_u32 s45, s14, s33
s_add_u32 s43, s14, s41
s_add_u32 m0, s45, 0
s_nop 0
buffer_load_dwordx4 v229, s[16:19], s32 offen offset:0 sc1 lds
buffer_load_dwordx4 v229, s[16:19], s32 offen offset:1024 sc1 lds
buffer_load_dwordx4 v229, s[16:19], s32 offen offset:2048 sc1 lds
buffer_load_dwordx4 v229, s[16:19], s32 offen offset:3072 sc1 lds
s_add_u32 s32, s32, 4096
s_add_u32 m0, s43, 0
s_nop 0
buffer_load_dwordx4 v230, s[20:23], s42 offen lds
s_add_u32 m0, s43, 1024
s_nop 0
buffer_load_dwordx4 v231, s[20:23], s42 offen lds
s_add_u32 s42, s42, 131072
s_add_u32 s14, s14, 24576
s_cmp_eq_u32 s14, 122880
s_cselect_b32 s14, 0, s14
s_waitcnt vmcnt(16)
s_barrier
s_add_u32 s45, s14, s33
s_add_u32 s43, s14, s41
s_add_u32 m0, s45, 0
s_nop 0
buffer_load_dwordx4 v229, s[16:19], s32 offen offset:0 sc1 lds
buffer_load_dwordx4 v229, s[16:19], s32 offen offset:1024 sc1 lds
buffer_load_dwordx4 v229, s[16:19], s32 offen offset:2048 sc1 lds
buffer_load_dwordx4 v229, s[16:19], s32 offen offset:3072 sc1 lds
s_add_u32 s32, s32, 4096
s_add_u32 m0, s43, 0
s_nop 0
buffer_load_dwordx4 v230, s[20:23], s42 offen lds
s_add_u32 m0, s43, 1024
s_nop 0
buffer_load_dwordx4 v231, s[20:23], s42 offen lds
s_add_u32 s42, s42, 131072
s_add_u32 s14, s14, 24576
s_cmp_eq_u32 s14, 122880
s_cselect_b32 s14, 0, s14
s_mov_b32 s15, 8
WO_PLOOP:
s_waitcnt vmcnt(18)
s_barrier
s_add_u32 s45, s14, s33
s_add_u32 s43, s14, s41
s_add_u32 m0, s45, 0
s_nop 0
buffer_load_dwordx4 v229, s[16:19], s32 offen offset:0 sc1 lds
buffer_load_dwordx4 v229, s[16:19], s32 offen offset:1024 sc1 lds
buffer_load_dwordx4 v229, s[16:19], s32 offen offset:2048 sc1 lds
buffer_load_dwordx4 v229, s[16:19], s32 offen offset:3072 sc1 lds
s_add_u32 s32, s32, 4096
s_add_u32 m0, s43, 0
s_nop 0
buffer_load_dwordx4 v230, s[20:23], s42 offen lds
s_add_u32 m0, s43, 1024
s_nop 0
buffer_load_dwordx4 v231, s[20:23], s42 offen lds
s_add_u32 s42, s42, 131072
s_add_u32 s14, s14, 24576
s_cmp_eq_u32 s14, 122880
s_cselect_b32 s14, 0, s14
s_sub_u32 s15, s15, 1
s_cmp_lg_u32 s15, 0
s_cbranch_scc1 WO_PLOOP
s_waitcnt vmcnt(18)
s_barrier
s_waitcnt vmcnt(12)
s_barrier
s_waitcnt vmcnt(6)
s_barrier
s_waitcnt vmcnt(0)
s_barrier
s_waitcnt vmcnt(0)
s_barrier
s_lshl_b32 s88, s12, 4
s_add_u32 s88, s88, s13
s_mov_b32 s4, s72
s_mov_b32 s5, s73
s_mov_b32 s6, s84
s_mov_b32 s7, s85
s_mov_b32 s8, s74
s_mov_b32 s9, s75
s_and_b32 s40, s2, 7
s_lshr_b32 s41, s2, 3
s_and_b32 s12, s40, 1
s_lshl_b32 s12, s12, 3
s_and_b32 s42, s41, 7
s_add_u32 s12, s12, s42
s_lshr_b32 s13, s40, 1
s_lshl_b32 s13, s13, 2
s_lshr_b32 s42, s41, 3
s_add_u32 s13, s13, s42
s_waitcnt lgkmcnt(0)
s_sub_u32 s44, s3, 4
s_mov_b32 s16, s6
s_mov_b32 s17, s7
s_add_u32 s16, s16, 16777216
s_addc_u32 s17, s17, 0
s_mov_b32 s18, 4194304
s_mov_b32 s19, 0x20000
v_lshlrev_b32 v229, 4, v2
s_lshl_b32 s32, s12, 2
s_add_u32 s32, s32, s44
s_mul_i32 s32, s32, 65536
s_mov_b32 s20, s4
s_mov_b32 s21, s5
s_mov_b32 s22, 7340032
s_mov_b32 s23, 0x20000
s_lshl_b32 s33, s44, 12
v_bfe_u32 v240, v2, 2, 2
v_and_b32 v241, 3, v2
v_lshrrev_b32 v242, 4, v2
s_mov_b32 s34, 7168
v_mul_lo_u32 v240, v240, s34
v_lshl_add_u32 v240, v241, 4, v240
v_lshl_add_u32 v240, v242, 6, v240
s_mul_i32 s35, s44, 114688
s_mul_i32 s36, s13, 448
s_and_b32 s37, s13, 1
s_lshl_b32 s37, s37, 6
s_sub_u32 s36, s36, s37
v_xor_b32 v241, 32, v240
s_add_u32 s40, s35, s36
s_add_u32 s40, s40, 0
v_add_u32 v230, s40, v240
s_add_u32 s40, s35, s36
s_add_u32 s40, s40, 256
v_add_u32 v231, s40, v240
s_add_u32 s40, s35, s36
s_add_u32 s40, s40, 28672
v_add_u32 v232, s40, v241
s_add_u32 s40, s35, s36
s_add_u32 s40, s40, 28928
v_add_u32 v233, s40, v241
s_add_u32 s40, s35, s36
s_add_u32 s40, s40, 57344
v_add_u32 v234, s40, v240
s_add_u32 s40, s35, s36
s_add_u32 s40, s40, 57600
v_add_u32 v235, s40, v240
s_add_u32 s40, s35, s36
s_add_u32 s40, s40, 86016
v_add_u32 v236, s40, v241
s_add_u32 s40, s35, s36
s_add_u32 s40, s40, 86272
v_add_u32 v237, s40, v241
s_lshl_b32 s41, s44, 13
s_add_u32 s41, s41, 16384
s_and_b32 s40, s13, 1
s_cmp_eq_u32 s40, 0
s_cselect_b32 s56, -1, 0xffff0000
s_mov_b32 s57, -1
s_mov_b32 s58, -1
s_cselect_b32 s59, 0x0000ffff, -1
s_mov_b32 s42, 0
s_barrier
s_cmp_lg_u32 s3, 4
s_cbranch_scc1 F3S_NW4
s_mov_b32 s48, s6
s_mov_b32 s49, s7
s_add_u32 s48, s48, 50331648
s_addc_u32 s49, s49, 0
s_mov_b32 s50, 262144
s_mov_b32 s51, 0x20000
s_mov_b32 s46, s88
s_add_u32 s46, s46, 768
s_lshl_b32 s46, s46, 7
s_add_u32 s47, s90, 3
v_mov_b32 v250, s47
v_mov_b32 v251, 0
s_mov_b64 exec, 1
buffer_store_dword v250, v251, s[48:51], s46 offen sc1
s_mov_b64 exec, -1
F3S_NW4:
s_mul_i32 s43, s12, 458752
s_mov_b64 exec, s[56:57]
s_add_u32 m0, s41, 98304
s_nop 0
buffer_load_dwordx4 v230, s[20:23], s43 offen lds
s_add_u32 m0, s41, 100352
s_nop 0
buffer_load_dwordx4 v232, s[20:23], s43 offen lds
s_add_u32 m0, s41, 102400
s_nop 0
buffer_load_dwordx4 v234, s[20:23], s43 offen lds
s_add_u32 m0, s41, 104448
s_nop 0
buffer_load_dwordx4 v236, s[20:23], s43 offen lds
s_mov_b64 exec, s[58:59]
s_add_u32 m0, s41, 99328
s_nop 0
buffer_load_dwordx4 v231, s[20:23], s43 offen lds
s_add_u32 m0, s41, 101376
s_nop 0
buffer_load_dwordx4 v233, s[20:23], s43 offen lds
s_add_u32 m0, s41, 103424
s_nop 0
buffer_load_dwordx4 v235, s[20:23], s43 offen lds
s_add_u32 m0, s41, 105472
s_nop 0
buffer_load_dwordx4 v237, s[20:23], s43 offen lds
s_mov_b64 exec, -1
s_mov_b64 exec, s[56:57]
s_add_u32 m0, s41, 0
s_nop 0
buffer_load_dwordx4 v230, s[20:23], s42 offen lds
s_add_u32 m0, s41, 2048
s_nop 0
buffer_load_dwordx4 v232, s[20:23], s42 offen lds
s_add_u32 m0, s41, 4096
s_nop 0
buffer_load_dwordx4 v234, s[20:23], s42 offen lds
s_add_u32 m0, s41, 6144
s_nop 0
buffer_load_dwordx4 v236, s[20:23], s42 offen lds
s_mov_b64 exec, s[58:59]
s_add_u32 m0, s41, 1024
s_nop 0
buffer_load_dwordx4 v231, s[20:23], s42 offen lds
s_add_u32 m0, s41, 3072
s_nop 0
buffer_load_dwordx4 v233, s[20:23], s42 offen lds
s_add_u32 m0, s41, 5120
s_nop 0
buffer_load_dwordx4 v235, s[20:23], s42 offen lds
s_add_u32 m0, s41, 7168
s_nop 0
buffer_load_dwordx4 v237, s[20:23], s42 offen lds
s_mov_b64 exec, -1
s_add_u32 s42, s42, 458752
s_mov_b64 exec, s[56:57]
s_add_u32 m0, s41, 49152
s_nop 0
buffer_load_dwordx4 v230, s[20:23], s42 offen lds
s_add_u32 m0, s41, 51200
s_nop 0
buffer_load_dwordx4 v232, s[20:23], s42 offen lds
s_add_u32 m0, s41, 53248
s_nop 0
buffer_load_dwordx4 v234, s[20:23], s42 offen lds
s_add_u32 m0, s41, 55296
s_nop 0
buffer_load_dwordx4 v236, s[20:23], s42 offen lds
s_mov_b64 exec, s[58:59]
s_add_u32 m0, s41, 50176
s_nop 0
buffer_load_dwordx4 v231, s[20:23], s42 offen lds
s_add_u32 m0, s41, 52224
s_nop 0
buffer_load_dwordx4 v233, s[20:23], s42 offen lds
s_add_u32 m0, s41, 54272
s_nop 0
buffer_load_dwordx4 v235, s[20:23], s42 offen lds
s_add_u32 m0, s41, 56320
s_nop 0
buffer_load_dwordx4 v237, s[20:23], s42 offen lds
s_mov_b64 exec, -1
s_add_u32 s42, s42, 458752
s_cmp_lg_u32 s3, 4
s_cbranch_scc1 F3P_NW4
s_mov_b32 s48, s6
s_mov_b32 s49, s7
s_add_u32 s48, s48, 50331648
s_addc_u32 s49, s49, 0
s_mov_b32 s50, 262144
s_mov_b32 s51, 0x20000
s_lshl_b32 s46, s12, 4
s_add_u32 s46, s46, 768
s_lshl_b32 s46, s46, 7
v_min_u32 v251, 15, v2
v_mul_u32_u24 v251, 128, v251
s_add_u32 s47, s90, 3
s_mov_b32 s45, 0
F3_POLL:
buffer_load_dword v250, v251, s[48:51], s46 offen sc1
s_waitcnt vmcnt(0)
v_cmp_ne_u32 vcc, s47, v250
s_add_u32 s45, s45, 1
s_cmp_gt_u32 s45, 400000
s_cbranch_scc1 F3_POK
s_cbranch_vccnz F3_POLL
F3_POK:
F3P_NW4:
s_waitcnt vmcnt(16)
s_barrier
s_add_u32 m0, s33, 0
s_nop 0
buffer_load_dwordx4 v229, s[16:19], s32 offen offset:0 sc1 lds
buffer_load_dwordx4 v229, s[16:19], s32 offen offset:1024 sc1 lds
buffer_load_dwordx4 v229, s[16:19], s32 offen offset:2048 sc1 lds
buffer_load_dwordx4 v229, s[16:19], s32 offen offset:3072 sc1 lds
s_add_u32 s32, s32, 4096
s_add_u32 m0, s33, 49152
s_nop 0
buffer_load_dwordx4 v229, s[16:19], s32 offen offset:0 sc1 lds
buffer_load_dwordx4 v229, s[16:19], s32 offen offset:1024 sc1 lds
buffer_load_dwordx4 v229, s[16:19], s32 offen offset:2048 sc1 lds
buffer_load_dwordx4 v229, s[16:19], s32 offen offset:3072 sc1 lds
s_add_u32 s32, s32, 4096
s_waitcnt vmcnt(4)
s_mov_b32 s14, 0
s_barrier
s_add_u32 m0, s33, 98304
s_nop 0
buffer_load_dwordx4 v229, s[16:19], s32 offen offset:0 sc1 lds
buffer_load_dwordx4 v229, s[16:19], s32 offen offset:1024 sc1 lds
buffer_load_dwordx4 v229, s[16:19], s32 offen offset:2048 sc1 lds
buffer_load_dwordx4 v229, s[16:19], s32 offen offset:3072 sc1 lds
s_add_u32 s32, s32, 4096
s_mov_b64 exec, s[56:57]
s_add_u32 m0, s41, 98304
s_nop 0
buffer_load_dwordx4 v230, s[20:23], s42 offen lds
s_add_u32 m0, s41, 100352
s_nop 0
buffer_load_dwordx4 v232, s[20:23], s42 offen lds
s_add_u32 m0, s41, 102400
s_nop 0
buffer_load_dwordx4 v234, s[20:23], s42 offen lds
s_add_u32 m0, s41, 104448
s_nop 0
buffer_load_dwordx4 v236, s[20:23], s42 offen lds
s_mov_b64 exec, s[58:59]
s_add_u32 m0, s41, 99328
s_nop 0
buffer_load_dwordx4 v231, s[20:23], s42 offen lds
s_add_u32 m0, s41, 101376
s_nop 0
buffer_load_dwordx4 v233, s[20:23], s42 offen lds
s_add_u32 m0, s41, 103424
s_nop 0
buffer_load_dwordx4 v235, s[20:23], s42 offen lds
s_add_u32 m0, s41, 105472
s_nop 0
buffer_load_dwordx4 v237, s[20:23], s42 offen lds
s_mov_b64 exec, -1
s_add_u32 s42, s42, 458752
s_waitcnt vmcnt(12)
s_barrier
s_add_u32 s45, s14, s33
s_add_u32 s43, s14, s41
s_add_u32 m0, s45, 0
s_nop 0
buffer_load_dwordx4 v229, s[16:19], s32 offen offset:0 sc1 lds
buffer_load_dwordx4 v229, s[16:19], s32 offen offset:1024 sc1 lds
buffer_load_dwordx4 v229, s[16:19], s32 offen offset:2048 sc1 lds
buffer_load_dwordx4 v229, s[16:19], s32 offen offset:3072 sc1 lds
s_add_u32 s32, s32, 4096
s_mov_b64 exec, s[56:57]
s_add_u32 m0, s43, 0
s_nop 0
buffer_load_dwordx4 v230, s[20:23], s42 offen lds
s_add_u32 m0, s43, 2048
s_nop 0
buffer_load_dwordx4 v232, s[20:23], s42 offen lds
s_add_u32 m0, s43, 4096
s_nop 0
buffer_load_dwordx4 v234, s[20:23], s42 offen lds
s_add_u32 m0, s43, 6144
s_nop 0
buffer_load_dwordx4 v236, s[20:23], s42 offen lds
s_mov_b64 exec, s[58:59]
s_add_u32 m0, s43, 1024
s_nop 0
buffer_load_dwordx4 v231, s[20:23], s42 offen lds
s_add_u32 m0, s43, 3072
s_nop 0
buffer_load_dwordx4 v233, s[20:23], s42 offen lds
s_add_u32 m0, s43, 5120
s_nop 0
buffer_load_dwordx4 v235, s[20:23], s42 offen lds
s_add_u32 m0, s43, 7168
s_nop 0
buffer_load_dwordx4 v237, s[20:23], s42 offen lds
s_mov_b64 exec, -1
s_add_u32 s42, s42, 458752
s_add_u32 s14, s14, 49152
s_cmp_eq_u32 s14, 147456
s_cselect_b32 s14, 0, s14
s_waitcnt vmcnt(12)
s_barrier
s_add_u32 s45, s14, s33
s_add_u32 s43, s14, s41
s_add_u32 m0, s45, 0
s_nop 0
buffer_load_dwordx4 v229, s[16:19], s32 offen offset:0 sc1 lds
buffer_load_dwordx4 v229, s[16:19], s32 offen offset:1024 sc1 lds
buffer_load_dwordx4 v229, s[16:19], s32 offen offset:2048 sc1 lds
buffer_load_dwordx4 v229, s[16:19], s32 offen offset:3072 sc1 lds
s_add_u32 s32, s32, 4096
s_mov_b64 exec, s[56:57]
s_add_u32 m0, s43, 0
s_nop 0
buffer_load_dwordx4 v230, s[20:23], s42 offen lds
s_add_u32 m0, s43, 2048
s_nop 0
buffer_load_dwordx4 v232, s[20:23], s42 offen lds
s_add_u32 m0, s43, 4096
s_nop 0
buffer_load_dwordx4 v234, s[20:23], s42 offen lds
s_add_u32 m0, s43, 6144
s_nop 0
buffer_load_dwordx4 v236, s[20:23], s42 offen lds
s_mov_b64 exec, s[58:59]
s_add_u32 m0, s43, 1024
s_nop 0
buffer_load_dwordx4 v231, s[20:23], s42 offen lds
s_add_u32 m0, s43, 3072
s_nop 0
buffer_load_dwordx4 v233, s[20:23], s42 offen lds
s_add_u32 m0, s43, 5120
s_nop 0
buffer_load_dwordx4 v235, s[20:23], s42 offen lds
s_add_u32 m0, s43, 7168
s_nop 0
buffer_load_dwordx4 v237, s[20:23], s42 offen lds
s_mov_b64 exec, -1
s_add_u32 s42, s42, 458752
s_add_u32 s14, s14, 49152
s_cmp_eq_u32 s14, 147456
s_cselect_b32 s14, 0, s14
s_waitcnt vmcnt(12)
s_barrier
s_add_u32 s45, s14, s33
s_add_u32 s43, s14, s41
s_add_u32 m0, s45, 0
s_nop 0
buffer_load_dwordx4 v229, s[16:19], s32 offen offset:0 sc1 lds
buffer_load_dwordx4 v229, s[16:19], s32 offen offset:1024 sc1 lds
buffer_load_dwordx4 v229, s[16:19], s32 offen offset:2048 sc1 lds
buffer_load_dwordx4 v229, s[16:19], s32 offen offset:3072 sc1 lds
s_add_u32 s32, s32, 4096
s_mov_b64 exec, s[56:57]
s_add_u32 m0, s43, 0
s_nop 0
buffer_load_dwordx4 v230, s[20:23], s42 offen lds
s_add_u32 m0, s43, 2048
s_nop 0
buffer_load_dwordx4 v232, s[20:23], s42 offen lds
s_add_u32 m0, s43, 4096
s_nop 0
buffer_load_dwordx4 v234, s[20:23], s42 offen lds
s_add_u32 m0, s43, 6144
s_nop 0
buffer_load_dwordx4 v236, s[20:23], s42 offen lds
s_mov_b64 exec, s[58:59]
s_add_u32 m0, s43, 1024
s_nop 0
buffer_load_dwordx4 v231, s[20:23], s42 offen lds
s_add_u32 m0, s43, 3072
s_nop 0
buffer_load_dwordx4 v233, s[20:23], s42 offen lds
s_add_u32 m0, s43, 5120
s_nop 0
buffer_load_dwordx4 v235, s[20:23], s42 offen lds
s_add_u32 m0, s43, 7168
s_nop 0
buffer_load_dwordx4 v237, s[20:23], s42 offen lds
s_mov_b64 exec, -1
s_add_u32 s42, s42, 458752
s_add_u32 s14, s14, 49152
s_cmp_eq_u32 s14, 147456
s_cselect_b32 s14, 0, s14
s_cmp_lg_u32 s3, 4
s_cbranch_scc1 SF5_NW4
s_mov_b32 s48, s6
s_mov_b32 s49, s7
s_add_u32 s48, s48, 50331648
s_addc_u32 s49, s49, 0
s_mov_b32 s50, 262144
s_mov_b32 s51, 0x20000
s_lshl_b32 s46, s12, 4
s_add_u32 s46, s46, s13
s_add_u32 s46, s46, 1280
s_lshl_b32 s46, s46, 7
s_add_u32 s47, s90, 5
v_mov_b32 v250, s47
v_mov_b32 v251, 0
s_mov_b64 exec, 1
buffer_store_dword v250, v251, s[48:51], s46 offen sc1
s_mov_b64 exec, -1
SF5_NW4:
s_mov_b32 s15, 10
FFN1_PLOOP:
s_waitcnt vmcnt(12)
s_barrier
s_add_u32 s45, s14, s33
s_add_u32 s43, s14, s41
s_add_u32 m0, s45, 0
s_nop 0
buffer_load_dwordx4 v229, s[16:19], s32 offen offset:0 sc1 lds
buffer_load_dwordx4 v229, s[16:19], s32 offen offset:1024 sc1 lds
buffer_load_dwordx4 v229, s[16:19], s32 offen offset:2048 sc1 lds
buffer_load_dwordx4 v229, s[16:19], s32 offen offset:3072 sc1 lds
s_add_u32 s32, s32, 4096
s_mov_b64 exec, s[56:57]
s_add_u32 m0, s43, 0
s_nop 0
buffer_load_dwordx4 v230, s[20:23], s42 offen lds
s_add_u32 m0, s43, 2048
s_nop 0
buffer_load_dwordx4 v232, s[20:23], s42 offen lds
s_add_u32 m0, s43, 4096
s_nop 0
buffer_load_dwordx4 v234, s[20:23], s42 offen lds
s_add_u32 m0, s43, 6144
s_nop 0
buffer_load_dwordx4 v236, s[20:23], s42 offen lds
s_mov_b64 exec, s[58:59]
s_add_u32 m0, s43, 1024
s_nop 0
buffer_load_dwordx4 v231, s[20:23], s42 offen lds
s_add_u32 m0, s43, 3072
s_nop 0
buffer_load_dwordx4 v233, s[20:23], s42 offen lds
s_add_u32 m0, s43, 5120
s_nop 0
buffer_load_dwordx4 v235, s[20:23], s42 offen lds
s_add_u32 m0, s43, 7168
s_nop 0
buffer_load_dwordx4 v237, s[20:23], s42 offen lds
s_mov_b64 exec, -1
s_add_u32 s42, s42, 458752
s_add_u32 s14, s14, 49152
s_cmp_eq_u32 s14, 147456
s_cselect_b32 s14, 0, s14
s_sub_u32 s15, s15, 1
s_cmp_lg_u32 s15, 0
s_cbranch_scc1 FFN1_PLOOP
s_cmp_eq_u32 s3, 4
s_cbranch_scc1 FFN1_LATE
s_cmp_lg_u32 s3, 5
s_cbranch_scc1 FFN1_LATEO
s_waitcnt vmcnt(12)
s_barrier
s_mov_b32 s24, s6
s_mov_b32 s25, s7
s_mov_b32 s26, 48234496
s_mov_b32 s27, 0x20000
v_lshlrev_b32 v248, 4, v2
s_lshl_b32 s36, s12, 10
s_add_u32 s36, s36, 42991616
buffer_load_dwordx4 v[100:103], v248, s[24:27], s36 offen sc1
s_add_u32 s36, s36, 16384
buffer_load_dwordx4 v[104:107], v248, s[24:27], s36 offen sc1
s_add_u32 s36, s36, 16384
buffer_load_dwordx4 v[108:111], v248, s[24:27], s36 offen sc1
s_add_u32 s36, s36, 16384
buffer_load_dwordx4 v[112:115], v248, s[24:27], s36 offen sc1
s_add_u32 s36, s36, 16384
buffer_load_dwordx4 v[116:119], v248, s[24:27], s36 offen sc1
s_add_u32 s36, s36, 16384
buffer_load_dwordx4 v[120:123], v248, s[24:27], s36 offen sc1
s_add_u32 s36, s36, 16384
buffer_load_dwordx4 v[124:127], v248, s[24:27], s36 offen sc1
s_add_u32 s36, s36, 16384
buffer_load_dwordx4 v[128:131], v248, s[24:27], s36 offen sc1
s_add_u32 s36, s36, 16384
buffer_load_dwordx4 v[132:135], v248, s[24:27], s36 offen sc1
s_add_u32 s36, s36, 16384
buffer_load_dwordx4 v[136:139], v248, s[24:27], s36 offen sc1
s_add_u32 s36, s36, 16384
buffer_load_dwordx4 v[140:143], v248, s[24:27], s36 offen sc1
s_add_u32 s36, s36, 16384
buffer_load_dwordx4 v[144:147], v248, s[24:27], s36 offen sc1
s_add_u32 s36, s36, 16384
buffer_load_dwordx4 v[148:151], v248, s[24:27], s36 offen sc1
s_add_u32 s36, s36, 16384
buffer_load_dwordx4 v[152:155], v248, s[24:27], s36 offen sc1
s_add_u32 s36, s36, 16384
buffer_load_dwordx4 v[156:159], v248, s[24:27], s36 offen sc1
s_add_u32 s36, s36, 16384
buffer_load_dwordx4 v[160:163], v248, s[24:27], s36 offen sc1
s_waitcnt vmcnt(16)
s_barrier
s_barrier
s_waitcnt vmcnt(0)
v_pk_add_f32 v[100:101], v[100:101], v[104:105]
v_pk_add_f32 v[102:103], v[102:103], v[106:107]
v_pk_add_f32 v[100:101], v[100:101], v[108:109]
v_pk_add_f32 v[102:103], v[102:103], v[110:111]
v_pk_add_f32 v[100:101], v[100:101], v[112:113]
v_pk_add_f32 v[102:103], v[102:103], v[114:115]
v_pk_add_f32 v[100:101], v[100:101], v[116:117]
v_pk_add_f32 v[102:103], v[102:103], v[118:119]
v_pk_add_f32 v[100:101], v[100:101], v[120:121]
v_pk_add_f32 v[102:103], v[102:103], v[122:123]
v_pk_add_f32 v[100:101], v[100:101], v[124:125]
v_pk_add_f32 v[102:103], v[102:103], v[126:127]
v_pk_add_f32 v[100:101], v[100:101], v[128:129]
v_pk_add_f32 v[102:103], v[102:103], v[130:131]
v_pk_add_f32 v[100:101], v[100:101], v[132:133]
v_pk_add_f32 v[102:103], v[102:103], v[134:135]
v_pk_add_f32 v[100:101], v[100:101], v[136:137]
v_pk_add_f32 v[102:103], v[102:103], v[138:139]
v_pk_add_f32 v[100:101], v[100:101], v[140:141]
v_pk_add_f32 v[102:103], v[102:103], v[142:143]
v_pk_add_f32 v[100:101], v[100:101], v[144:145]
v_pk_add_f32 v[102:103], v[102:103], v[146:147]
v_pk_add_f32 v[100:101], v[100:101], v[148:149]
v_pk_add_f32 v[102:103], v[102:103], v[150:151]
v_pk_add_f32 v[100:101], v[100:101], v[152:153]
v_pk_add_f32 v[102:103], v[102:103], v[154:155]
v_pk_add_f32 v[100:101], v[100:101], v[156:157]
v_pk_add_f32 v[102:103], v[102:103], v[158:159]
v_pk_add_f32 v[100:101], v[100:101], v[160:161]
v_pk_add_f32 v[102:103], v[102:103], v[162:163]
v_mul_f32 v100, 0x3a800000, v100
v_mul_f32 v101, 0x3a800000, v101
v_fma_f32 v101, -v100, v100, v101
v_add_f32 v101, 0x3727c5ac, v101
v_rsq_f32 v101, v101
s_nop 0
v_mul_f32 v100, v100, v101
v_sub_f32 v100, 0, v100
v_mul_f32 v102, 0x3a800000, v102
v_mul_f32 v103, 0x3a800000, v103
v_fma_f32 v103, -v102, v102, v103
v_add_f32 v103, 0x3727c5ac, v103
v_rsq_f32 v103, v103
s_nop 0
v_mul_f32 v102, v102, v103
v_sub_f32 v102, 0, v102
v_mov_b32 v104, v101
v_mov_b32 v105, v103
v_mov_b32 v106, v100
v_mov_b32 v107, v102
v_lshlrev_b32 v249, 3, v2
v_add_u32 v249, 147456, v249
ds_write_b64 v249, v[104:105] offset:2048
ds_write_b64 v249, v[106:107] offset:2560
s_waitcnt lgkmcnt(0)
s_barrier
s_branch FFN1_LATEEND
FFN1_LATEO:
s_waitcnt vmcnt(12)
s_barrier
s_waitcnt vmcnt(0)
s_barrier
s_barrier
s_barrier
s_branch FFN1_LATEEND
FFN1_LATE:
s_mov_b32 s48, s6
s_mov_b32 s49, s7
s_add_u32 s48, s48, 50331648
s_addc_u32 s49, s49, 0
s_mov_b32 s50, 262144
s_mov_b32 s51, 0x20000
v_and_b32 v249, 15, v2
v_lshlrev_b32 v249, 4, v249
v_add_u32 v251, s13, v249
v_add_u32 v251, 1280, v251
v_lshlrev_b32 v251, 7, v251
buffer_load_dword v250, v251, s[48:51], 0 offen sc1
s_waitcnt vmcnt(12)
s_barrier
s_add_u32 s47, s90, 5
s_mov_b32 s46, 0
FFN1_LT_PCHK:
s_waitcnt vmcnt(0)
FFN1_LT_PCMP:
v_cmp_ne_u32 vcc, s47, v250
s_add_u32 s46, s46, 1
s_cmp_gt_u32 s46, 400000
s_cbranch_scc1 FFN1_LT_PCOK
s_cbranch_vccz FFN1_LT_PCOK
buffer_load_dword v250, v251, s[48:51], 0 offen sc1
s_branch FFN1_LT_PCHK
FFN1_LT_PCOK:
s_mov_b32 s24, s6
s_mov_b32 s25, s7
s_mov_b32 s26, 48234496
s_mov_b32 s27, 0x20000
v_min_u32 v248, 55, v2
v_lshlrev_b32 v248, 4, v248
s_mul_i32 s36, s13, 14336
s_add_u32 s36, s36, 46137344
buffer_load_dwordx4 v[100:103], v248, s[24:27], s36 offen sc1
s_add_u32 s36, s36, 896
buffer_load_dwordx4 v[104:107], v248, s[24:27], s36 offen sc1
s_add_u32 s36, s36, 896
buffer_load_dwordx4 v[108:111], v248, s[24:27], s36 offen sc1
s_add_u32 s36, s36, 896
buffer_load_dwordx4 v[112:115], v248, s[24:27], s36 offen sc1
s_add_u32 s36, s36, 896
buffer_load_dwordx4 v[116:119], v248, s[24:27], s36 offen sc1
s_add_u32 s36, s36, 896
buffer_load_dwordx4 v[120:123], v248, s[24:27], s36 offen sc1
s_add_u32 s36, s36, 896
buffer_load_dwordx4 v[124:127], v248, s[24:27], s36 offen sc1
s_add_u32 s36, s36, 896
buffer_load_dwordx4 v[128:131], v248, s[24:27], s36 offen sc1
s_add_u32 s36, s36, 896
buffer_load_dwordx4 v[132:135], v248, s[24:27], s36 offen sc1
s_add_u32 s36, s36, 896
buffer_load_dwordx4 v[136:139], v248, s[24:27], s36 offen sc1
s_add_u32 s36, s36, 896
buffer_load_dwordx4 v[140:143], v248, s[24:27], s36 offen sc1
s_add_u32 s36, s36, 896
buffer_load_dwordx4 v[144:147], v248, s[24:27], s36 offen sc1
s_add_u32 s36, s36, 896
buffer_load_dwordx4 v[148:151], v248, s[24:27], s36 offen sc1
s_add_u32 s36, s36, 896
buffer_load_dwordx4 v[152:155], v248, s[24:27], s36 offen sc1
s_add_u32 s36, s36, 896
buffer_load_dwordx4 v[156:159], v248, s[24:27], s36 offen sc1
s_add_u32 s36, s36, 896
buffer_load_dwordx4 v[160:163], v248, s[24:27], s36 offen sc1
s_barrier
s_barrier
s_waitcnt vmcnt(0)
v_pk_add_f32 v[100:101], v[100:101], v[104:105]
v_pk_add_f32 v[102:103], v[102:103], v[106:107]
v_pk_add_f32 v[100:101], v[100:101], v[108:109]
v_pk_add_f32 v[102:103], v[102:103], v[110:111]
v_pk_add_f32 v[100:101], v[100:101], v[112:113]
v_pk_add_f32 v[102:103], v[102:103], v[114:115]
v_pk_add_f32 v[100:101], v[100:101], v[116:117]
v_pk_add_f32 v[102:103], v[102:103], v[118:119]
v_pk_add_f32 v[100:101], v[100:101], v[120:121]
v_pk_add_f32 v[102:103], v[102:103], v[122:123]
v_pk_add_f32 v[100:101], v[100:101], v[124:125]
v_pk_add_f32 v[102:103], v[102:103], v[126:127]
v_pk_add_f32 v[100:101], v[100:101], v[128:129]
v_pk_add_f32 v[102:103], v[102:103], v[130:131]
v_pk_add_f32 v[100:101], v[100:101], v[132:133]
v_pk_add_f32 v[102:103], v[102:103], v[134:135]
v_pk_add_f32 v[100:101], v[100:101], v[136:137]
v_pk_add_f32 v[102:103], v[102:103], v[138:139]
v_pk_add_f32 v[100:101], v[100:101], v[140:141]
v_pk_add_f32 v[102:103], v[102:103], v[142:143]
v_pk_add_f32 v[100:101], v[100:101], v[144:145]
v_pk_add_f32 v[102:103], v[102:103], v[146:147]
v_pk_add_f32 v[100:101], v[100:101], v[148:149]
v_pk_add_f32 v[102:103], v[102:103], v[150:151]
v_pk_add_f32 v[100:101], v[100:101], v[152:153]
v_pk_add_f32 v[102:103], v[102:103], v[154:155]
v_pk_add_f32 v[100:101], v[100:101], v[156:157]
v_pk_add_f32 v[102:103], v[102:103], v[158:159]
v_pk_add_f32 v[100:101], v[100:101], v[160:161]
v_pk_add_f32 v[102:103], v[102:103], v[162:163]
v_add_u32 v248, 147456, v248
ds_write_b128 v248, v[100:103]
s_waitcnt lgkmcnt(0)
s_barrier
FFN1_LATEEND:
s_lshl_b32 s88, s12, 4
s_add_u32 s88, s88, s13
s_mov_b32 s4, s76
s_mov_b32 s5, s77
s_mov_b32 s6, s84
s_mov_b32 s7, s85
s_mov_b32 s8, s78
s_mov_b32 s9, s79
s_mov_b32 s10, s80
s_mov_b32 s11, s81
s_and_b32 s40, s2, 7
s_lshr_b32 s41, s2, 3
s_and_b32 s86, s40, 1
s_bfe_u32 s12, s40, 0x10001
s_lshl_b32 s12, s12, 3
s_and_b32 s42, s41, 7
s_add_u32 s12, s12, s42
s_lshr_b32 s13, s40, 2
s_lshl_b32 s13, s13, 2
s_lshr_b32 s42, s41, 3
s_add_u32 s13, s13, s42
s_waitcnt lgkmcnt(0)
s_sub_u32 s44, s3, 4
s_mov_b32 s16, s6
s_mov_b32 s17, s7
s_add_u32 s16, s16, 25165824
s_addc_u32 s17, s17, 0
s_mov_b32 s18, 14680064
s_mov_b32 s19, 0x20000
v_lshlrev_b32 v229, 4, v2
s_lshl_b32 s32, s12, 2
s_add_u32 s32, s32, s44
s_mul_i32 s32, s32, 229376
s_mul_i32 s34, s86, 114688
s_add_u32 s32, s32, s34
s_mov_b32 s20, s4
s_mov_b32 s21, s5
s_mov_b32 s22, 7340032
s_mov_b32 s23, 0x20000
s_lshl_b32 s33, s44, 12
v_bfe_u32 v240, v2, 2, 2
v_and_b32 v241, 3, v2
v_lshrrev_b32 v242, 4, v2
s_mov_b32 s34, 2048
v_lshrrev_b32 v243, 1, v242
v_lshl_add_u32 v240, v243, 2, v240
v_and_b32 v242, 1, v242
v_mul_lo_u32 v240, v240, s34
v_lshl_add_u32 v240, v241, 4, v240
v_lshl_add_u32 v240, v242, 6, v240
s_mul_i32 s35, s44, 32768
s_lshl_b32 s36, s13, 8
s_add_u32 s37, s36, 128
v_and_b32 v241, 32, v2
v_xor_b32 v240, v240, v241
s_add_u32 s40, s35, s36
v_add_u32 v230, s40, v240
s_add_u32 s40, s35, s36
s_add_u32 s40, s40, 16384
v_add_u32 v231, s40, v240
s_add_u32 s40, s35, s37
v_add_u32 v232, s40, v240
s_add_u32 s40, s35, s37
s_add_u32 s40, s40, 16384
v_add_u32 v233, s40, v240
s_lshl_b32 s41, s44, 11
s_add_u32 s41, s41, 16384
s_mul_i32 s42, s86, 3670016
s_barrier
s_cmp_lg_u32 s3, 4
s_cbranch_scc1 F4S_NW4
s_mov_b32 s48, s6
s_mov_b32 s49, s7
s_add_u32 s48, s48, 50331648
s_addc_u32 s49, s49, 0
s_mov_b32 s50, 262144
s_mov_b32 s51, 0x20000
s_mov_b32 s46, s88
s_add_u32 s46, s46, 1024
s_lshl_b32 s46, s46, 7
s_add_u32 s47, s90, 4
v_mov_b32 v250, s47
v_mov_b32 v251, 0
s_mov_b64 exec, 1
buffer_store_dword v250, v251, s[48:51], s46 offen sc1
s_mov_b64 exec, -1
F4S_NW4:
s_add_u32 m0, s41, 0
s_nop 0
buffer_load_dwordx4 v230, s[20:23], s42 offen lds
s_add_u32 m0, s41, 1024
s_nop 0
buffer_load_dwordx4 v231, s[20:23], s42 offen lds
s_add_u32 m0, s41, 8192
s_nop 0
buffer_load_dwordx4 v232, s[20:23], s42 offen lds
s_add_u32 m0, s41, 9216
s_nop 0
buffer_load_dwordx4 v233, s[20:23], s42 offen lds
s_add_u32 s42, s42, 131072
s_add_u32 m0, s41, 32768
s_nop 0
buffer_load_dwordx4 v230, s[20:23], s42 offen lds
s_add_u32 m0, s41, 33792
s_nop 0
buffer_load_dwordx4 v231, s[20:23], s42 offen lds
s_add_u32 m0, s41, 40960
s_nop 0
buffer_load_dwordx4 v232, s[20:23], s42 offen lds
s_add_u32 m0, s41, 41984
s_nop 0
buffer_load_dwordx4 v233, s[20:23], s42 offen lds
s_add_u32 s42, s42, 131072
s_add_u32 m0, s41, 65536
s_nop 0
buffer_load_dwordx4 v230, s[20:23], s42 offen lds
s_add_u32 m0, s41, 66560
s_nop 0
buffer_load_dwordx4 v231, s[20:23], s42 offen lds
s_add_u32 m0, s41, 73728
s_nop 0
buffer_load_dwordx4 v232, s[20:23], s42 offen lds
s_add_u32 m0, s41, 74752
s_nop 0
buffer_load_dwordx4 v233, s[20:23], s42 offen lds
s_add_u32 s42, s42, 131072
s_add_u32 m0, s41, 98304
s_nop 0
buffer_load_dwordx4 v230, s[20:23], s42 offen lds
s_add_u32 m0, s41, 99328
s_nop 0
buffer_load_dwordx4 v231, s[20:23], s42 offen lds
s_add_u32 m0, s41, 106496
s_nop 0
buffer_load_dwordx4 v232, s[20:23], s42 offen lds
s_add_u32 m0, s41, 107520
s_nop 0
buffer_load_dwordx4 v233, s[20:23], s42 offen lds
s_add_u32 s42, s42, 131072
s_cmp_lg_u32 s3, 4
s_cbranch_scc1 F4P_NW4
s_mov_b32 s48, s6
s_mov_b32 s49, s7
s_add_u32 s48, s48, 50331648
s_addc_u32 s49, s49, 0
s_mov_b32 s50, 262144
s_mov_b32 s51, 0x20000
s_lshl_b32 s46, s12, 4
s_add_u32 s46, s46, 1024
s_lshl_b32 s46, s46, 7
v_min_u32 v251, 15, v2
v_mul_u32_u24 v251, 128, v251
s_add_u32 s47, s90, 4
s_mov_b32 s45, 0
F4_POLL:
buffer_load_dword v250, v251, s[48:51], s46 offen sc1
s_waitcnt vmcnt(0)
v_cmp_ne_u32 vcc, s47, v250
s_add_u32 s45, s45, 1
s_cmp_gt_u32 s45, 400000
s_cbranch_scc1 F4_POK
s_cbranch_vccnz F4_POLL
F4_POK:
F4P_NW4:
s_barrier
s_lshr_b32 s46, s44, 1
s_lshl_b32 s46, s46, 1
s_add_u32 s46, s46, s86
s_and_b32 s47, s44, 1
s_lshl_b32 s47, s47, 11
s_lshl_b32 s91, s46, 12
s_add_u32 s91, s91, s47
s_lshl_b32 s87, s12, 2
s_add_u32 s87, s87, s46
s_mul_i32 s87, s87, 229376
s_add_u32 s87, s87, s47
s_mov_b32 s93, s87
s_mul_i32 s46, s86, 114688
s_add_u32 s87, s87, s46
s_add_u32 s87, s87, 90112
s_add_u32 m0, s33, 0
s_nop 0
buffer_load_dwordx4 v229, s[16:19], s32 offen offset:0 sc1 lds
buffer_load_dwordx4 v229, s[16:19], s32 offen offset:1024 sc1 lds
buffer_load_dwordx4 v229, s[16:19], s32 offen offset:2048 sc1 lds
buffer_load_dwordx4 v229, s[16:19], s32 offen offset:3072 sc1 lds
s_add_u32 s32, s32, 4096
s_add_u32 m0, s33, 32768
s_nop 0
buffer_load_dwordx4 v229, s[16:19], s32 offen offset:0 sc1 lds
buffer_load_dwordx4 v229, s[16:19], s32 offen offset:1024 sc1 lds
buffer_load_dwordx4 v229, s[16:19], s32 offen offset:2048 sc1 lds
buffer_load_dwordx4 v229, s[16:19], s32 offen offset:3072 sc1 lds
s_add_u32 s32, s32, 4096
s_add_u32 m0, s33, 65536
s_nop 0
buffer_load_dwordx4 v229, s[16:19], s32 offen offset:0 sc1 lds
buffer_load_dwordx4 v229, s[16:19], s32 offen offset:1024 sc1 lds
buffer_load_dwordx4 v229, s[16:19], s32 offen offset:2048 sc1 lds
buffer_load_dwordx4 v229, s[16:19], s32 offen offset:3072 sc1 lds
s_add_u32 s32, s32, 4096
s_waitcnt vmcnt(8)
s_mov_b32 s14, 0
s_barrier
s_add_u32 m0, s33, 98304
s_nop 0
buffer_load_dwordx4 v229, s[16:19], s32 offen offset:0 sc1 lds
buffer_load_dwordx4 v229, s[16:19], s32 offen offset:1024 sc1 lds
buffer_load_dwordx4 v229, s[16:19], s32 offen offset:2048 sc1 lds
buffer_load_dwordx4 v229, s[16:19], s32 offen offset:3072 sc1 lds
s_add_u32 s32, s32, 4096
s_waitcnt vmcnt(8)
s_barrier
s_add_u32 s45, s14, s33
s_add_u32 m0, s45, 0
s_nop 0
buffer_load_dwordx4 v229, s[16:19], s32 offen offset:0 sc1 lds
buffer_load_dwordx4 v229, s[16:19], s32 offen offset:1024 sc1 lds
buffer_load_dwordx4 v229, s[16:19], s32 offen offset:2048 sc1 lds
buffer_load_dwordx4 v229, s[16:19], s32 offen offset:3072 sc1 lds
s_add_u32 s32, s32, 4096
s_add_u32 s43, s14, s41
s_add_u32 m0, s43, 0
s_nop 0
buffer_load_dwordx4 v230, s[20:23], s42 offen lds
s_add_u32 m0, s43, 1024
s_nop 0
buffer_load_dwordx4 v231, s[20:23], s42 offen lds
s_add_u32 m0, s43, 8192
s_nop 0
buffer_load_dwordx4 v232, s[20:23], s42 offen lds
s_add_u32 m0, s43, 9216
s_nop 0
buffer_load_dwordx4 v233, s[20:23], s42 offen lds
s_add_u32 s42, s42, 131072
s_add_u32 s14, s14, 32768
s_cmp_eq_u32 s14, 131072
s_cselect_b32 s14, 0, s14
s_waitcnt vmcnt(12)
s_barrier
s_add_u32 s45, s14, s33
s_add_u32 m0, s45, 0
s_nop 0
buffer_load_dwordx4 v229, s[16:19], s32 offen offset:0 sc1 lds
buffer_load_dwordx4 v229, s[16:19], s32 offen offset:1024 sc1 lds
buffer_load_dwordx4 v229, s[16:19], s32 offen offset:2048 sc1 lds
buffer_load_dwordx4 v229, s[16:19], s32 offen offset:3072 sc1 lds
s_add_u32 s32, s32, 4096
s_add_u32 s43, s14, s41
s_add_u32 m0, s43, 0
s_nop 0
buffer_load_dwordx4 v230, s[20:23], s42 offen lds
s_add_u32 m0, s43, 1024
s_nop 0
buffer_load_dwordx4 v231, s[20:23], s42 offen lds
s_add_u32 m0, s43, 8192
s_nop 0
buffer_load_dwordx4 v232, s[20:23], s42 offen lds
s_add_u32 m0, s43, 9216
s_nop 0
buffer_load_dwordx4 v233, s[20:23], s42 offen lds
s_add_u32 s42, s42, 131072
s_add_u32 s14, s14, 32768
s_cmp_eq_u32 s14, 131072
s_cselect_b32 s14, 0, s14
s_mov_b32 s15, 16
FFN2_PS0LOOP:
s_waitcnt vmcnt(16)
s_barrier
s_add_u32 s45, s14, s33
s_add_u32 m0, s45, 0
s_nop 0
buffer_load_dwordx4 v229, s[16:19], s32 offen offset:0 sc1 lds
buffer_load_dwordx4 v229, s[16:19], s32 offen offset:1024 sc1 lds
buffer_load_dwordx4 v229, s[16:19], s32 offen offset:2048 sc1 lds
buffer_load_dwordx4 v229, s[16:19], s32 offen offset:3072 sc1 lds
s_add_u32 s32, s32, 4096
s_add_u32 s43, s14, s41
s_add_u32 m0, s43, 0
s_nop 0
buffer_load_dwordx4 v230, s[20:23], s42 offen lds
s_add_u32 m0, s43, 1024
s_nop 0
buffer_load_dwordx4 v231, s[20:23], s42 offen lds
s_add_u32 m0, s43, 8192
s_nop 0
buffer_load_dwordx4 v232, s[20:23], s42 offen lds
s_add_u32 m0, s43, 9216
s_nop 0
buffer_load_dwordx4 v233, s[20:23], s42 offen lds
s_add_u32 s42, s42, 131072
s_add_u32 s14, s14, 32768
s_cmp_eq_u32 s14, 131072
s_cselect_b32 s14, 0, s14
s_sub_u32 s15, s15, 1
s_cmp_lg_u32 s15, 0
s_cbranch_scc1 FFN2_PS0LOOP
s_waitcnt vmcnt(16)
s_barrier
s_add_u32 m0, s14, s91
s_nop 0
buffer_load_dwordx4 v229, s[16:19], s87 offen offset:0 sc1 lds
buffer_load_dwordx4 v229, s[16:19], s87 offen offset:1024 sc1 lds
s_add_u32 s87, s87, 4096
s_add_u32 s43, s14, s41
s_add_u32 m0, s43, 0
s_nop 0
buffer_load_dwordx4 v230, s[20:23], s42 offen lds
s_add_u32 m0, s43, 1024
s_nop 0
buffer_load_dwordx4 v231, s[20:23], s42 offen lds
s_add_u32 m0, s43, 8192
s_nop 0
buffer_load_dwordx4 v232, s[20:23], s42 offen lds
s_add_u32 m0, s43, 9216
s_nop 0
buffer_load_dwordx4 v233, s[20:23], s42 offen lds
s_add_u32 s42, s42, 131072
s_add_u32 s14, s14, 32768
s_cmp_eq_u32 s14, 131072
s_cselect_b32 s14, 0, s14
s_waitcnt vmcnt(14)
s_barrier
s_add_u32 m0, s14, s91
s_nop 0
buffer_load_dwordx4 v229, s[16:19], s87 offen offset:0 sc1 lds
buffer_load_dwordx4 v229, s[16:19], s87 offen offset:1024 sc1 lds
s_add_u32 s87, s87, 4096
s_add_u32 s43, s14, s41
s_add_u32 m0, s43, 0
s_nop 0
buffer_load_dwordx4 v230, s[20:23], s42 offen lds
s_add_u32 m0, s43, 1024
s_nop 0
buffer_load_dwordx4 v231, s[20:23], s42 offen lds
s_add_u32 m0, s43, 8192
s_nop 0
buffer_load_dwordx4 v232, s[20:23], s42 offen lds
s_add_u32 m0, s43, 9216
s_nop 0
buffer_load_dwordx4 v233, s[20:23], s42 offen lds
s_add_u32 s42, s42, 131072
s_add_u32 s14, s14, 32768
s_cmp_eq_u32 s14, 131072
s_cselect_b32 s14, 0, s14
s_mov_b32 s15, 4
FFN2_PS1LOOP:
s_waitcnt vmcnt(12)
s_barrier
s_add_u32 m0, s14, s91
s_nop 0
buffer_load_dwordx4 v229, s[16:19], s87 offen offset:0 sc1 lds
buffer_load_dwordx4 v229, s[16:19], s87 offen offset:1024 sc1 lds
s_add_u32 s87, s87, 4096
s_add_u32 s43, s14, s41
s_add_u32 m0, s43, 0
s_nop 0
buffer_load_dwordx4 v230, s[20:23], s42 offen lds
s_add_u32 m0, s43, 1024
s_nop 0
buffer_load_dwordx4 v231, s[20:23], s42 offen lds
s_add_u32 m0, s43, 8192
s_nop 0
buffer_load_dwordx4 v232, s[20:23], s42 offen lds
s_add_u32 m0, s43, 9216
s_nop 0
buffer_load_dwordx4 v233, s[20:23], s42 offen lds
s_add_u32 s42, s42, 131072
s_add_u32 s14, s14, 32768
s_cmp_eq_u32 s14, 131072
s_cselect_b32 s14, 0, s14
s_sub_u32 s15, s15, 1
s_cmp_lg_u32 s15, 0
s_cbranch_scc1 FFN2_PS1LOOP
s_waitcnt vmcnt(12)
s_barrier
s_xor_b32 s46, s86, 1
s_mul_i32 s47, s46, 114688
s_add_u32 s87, s93, s47
s_add_u32 s87, s87, 90112
s_mul_i32 s42, s46, 3670016
s_add_u32 s42, s42, 2883584
s_add_u32 m0, s14, s91
s_nop 0
buffer_load_dwordx4 v229, s[16:19], s87 offen offset:0 sc1 lds
buffer_load_dwordx4 v229, s[16:19], s87 offen offset:1024 sc1 lds
s_add_u32 s87, s87, 4096
s_add_u32 s43, s14, s41
s_add_u32 m0, s43, 0
s_nop 0
buffer_load_dwordx4 v230, s[20:23], s42 offen lds
s_add_u32 m0, s43, 1024
s_nop 0
buffer_load_dwordx4 v231, s[20:23], s42 offen lds
s_add_u32 m0, s43, 8192
s_nop 0
buffer_load_dwordx4 v232, s[20:23], s42 offen lds
s_add_u32 m0, s43, 9216
s_nop 0
buffer_load_dwordx4 v233, s[20:23], s42 offen lds
s_add_u32 s42, s42, 131072
s_add_u32 s14, s14, 32768
s_cmp_eq_u32 s14, 131072
s_cselect_b32 s14, 0, s14
s_waitcnt vmcnt(12)
s_barrier
s_add_u32 m0, s14, s91
s_nop 0
buffer_load_dwordx4 v229, s[16:19], s87 offen offset:0 sc1 lds
buffer_load_dwordx4 v229, s[16:19], s87 offen offset:1024 sc1 lds
s_add_u32 s87, s87, 4096
s_add_u32 s43, s14, s41
s_add_u32 m0, s43, 0
s_nop 0
buffer_load_dwordx4 v230, s[20:23], s42 offen lds
s_add_u32 m0, s43, 1024
s_nop 0
buffer_load_dwordx4 v231, s[20:23], s42 offen lds
s_add_u32 m0, s43, 8192
s_nop 0
buffer_load_dwordx4 v232, s[20:23], s42 offen lds
s_add_u32 m0, s43, 9216
s_nop 0
buffer_load_dwordx4 v233, s[20:23], s42 offen lds
s_add_u32 s42, s42, 131072
s_add_u32 s14, s14, 32768
s_cmp_eq_u32 s14, 131072
s_cselect_b32 s14, 0, s14
s_cmp_lg_u32 s3, 4
s_cbranch_scc1 X6S_NW4
s_mov_b32 s48, s6
s_mov_b32 s49, s7
s_add_u32 s48, s48, 50331648
s_addc_u32 s49, s49, 0
s_mov_b32 s50, 262144
s_mov_b32 s51, 0x20000
s_lshl_b32 s46, s12, 3
s_add_u32 s46, s46, s13
s_lshl_b32 s46, s46, 1
s_add_u32 s46, s46, s86
s_add_u32 s46, s46, 1536
s_lshl_b32 s46, s46, 7
s_add_u32 s47, s90, 6
v_mov_b32 v250, s47
v_mov_b32 v251, 0
s_mov_b64 exec, 1
buffer_store_dword v250, v251, s[48:51], s46 offen sc1
s_mov_b64 exec, -1
X6S_NW4:
s_mov_b32 s15, 3
FFN2_PS2LOOP:
s_waitcnt vmcnt(12)
s_barrier
s_add_u32 m0, s14, s91
s_nop 0
buffer_load_dwordx4 v229, s[16:19], s87 offen offset:0 sc1 lds
buffer_load_dwordx4 v229, s[16:19], s87 offen offset:1024 sc1 lds
s_add_u32 s87, s87, 4096
s_add_u32 s43, s14, s41
s_add_u32 m0, s43, 0
s_nop 0
buffer_load_dwordx4 v230, s[20:23], s42 offen lds
s_add_u32 m0, s43, 1024
s_nop 0
buffer_load_dwordx4 v231, s[20:23], s42 offen lds
s_add_u32 m0, s43, 8192
s_nop 0
buffer_load_dwordx4 v232, s[20:23], s42 offen lds
s_add_u32 m0, s43, 9216
s_nop 0
buffer_load_dwordx4 v233, s[20:23], s42 offen lds
s_add_u32 s42, s42, 131072
s_add_u32 s14, s14, 32768
s_cmp_eq_u32 s14, 131072
s_cselect_b32 s14, 0, s14
s_sub_u32 s15, s15, 1
s_cmp_lg_u32 s15, 0
s_cbranch_scc1 FFN2_PS2LOOP
s_waitcnt vmcnt(12)
s_barrier
s_cmp_lg_u32 s3, 4
s_cbranch_scc1 X6P_NW4
s_mov_b32 s48, s6
s_mov_b32 s49, s7
s_add_u32 s48, s48, 50331648
s_addc_u32 s49, s49, 0
s_mov_b32 s50, 262144
s_mov_b32 s51, 0x20000
s_lshl_b32 s46, s12, 3
s_add_u32 s46, s46, s13
s_lshl_b32 s46, s46, 1
s_add_u32 s46, s46, s86
s_xor_b32 s46, s46, 1
s_add_u32 s46, s46, 1536
s_lshl_b32 s46, s46, 7
v_mov_b32 v251, s46
buffer_load_dword v250, v251, s[48:51], 0 offen sc1
X6P_NW4:
s_add_u32 m0, s14, s91
s_nop 0
buffer_load_dwordx4 v229, s[16:19], s87 offen offset:0 sc1 lds
buffer_load_dwordx4 v229, s[16:19], s87 offen offset:1024 sc1 lds
s_add_u32 s87, s87, 4096
s_add_u32 s43, s14, s41
s_add_u32 m0, s43, 0
s_nop 0
buffer_load_dwordx4 v230, s[20:23], s42 offen lds
s_add_u32 m0, s43, 1024
s_nop 0
buffer_load_dwordx4 v231, s[20:23], s42 offen lds
s_add_u32 m0, s43, 8192
s_nop 0
buffer_load_dwordx4 v232, s[20:23], s42 offen lds
s_add_u32 m0, s43, 9216
s_nop 0
buffer_load_dwordx4 v233, s[20:23], s42 offen lds
s_add_u32 s42, s42, 131072
s_add_u32 s14, s14, 32768
s_cmp_eq_u32 s14, 131072
s_cselect_b32 s14, 0, s14
s_waitcnt vmcnt(12)
s_barrier
s_cmp_lg_u32 s3, 4
s_cbranch_scc1 X6C_NW4
s_mov_b32 s48, s6
s_mov_b32 s49, s7
s_add_u32 s48, s48, 50331648
s_addc_u32 s49, s49, 0
s_mov_b32 s50, 262144
s_mov_b32 s51, 0x20000
s_lshl_b32 s46, s12, 3
s_add_u32 s46, s46, s13
s_lshl_b32 s46, s46, 1
s_add_u32 s46, s46, s86
s_xor_b32 s46, s46, 1
s_add_u32 s46, s46, 1536
s_lshl_b32 s46, s46, 7
v_mov_b32 v251, s46
s_add_u32 s47, s90, 6
s_mov_b32 s46, 0
s_waitcnt vmcnt(6)
s_branch X6C_PCMP
X6C_PCHK:
s_waitcnt vmcnt(0)
X6C_PCMP:
v_cmp_ne_u32 vcc, s47, v250
s_add_u32 s46, s46, 1
s_cmp_gt_u32 s46, 400000
s_cbranch_scc1 X6C_PCOK
s_cbranch_vccz X6C_PCOK
buffer_load_dword v250, v251, s[48:51], 0 offen sc1
s_branch X6C_PCHK
X6C_PCOK:
X6C_NW4:
s_waitcnt vmcnt(6)
s_barrier
s_waitcnt vmcnt(0)
s_barrier
s_waitcnt vmcnt(0)
s_barrier
MEGA_END:
s_endpgm
.text
.fill 64, 4, 0xBF800000
.section .rodata,"a"
.p2align 6
.p2align 6
.amdhsa_kernel mega_kernel
  .amdhsa_next_free_vgpr 256
  .amdhsa_next_free_sgpr 100
  .amdhsa_accum_offset 256
  .amdhsa_group_segment_fixed_size 0
  .amdhsa_kernarg_size 88
  .amdhsa_user_sgpr_count 2
  .amdhsa_user_sgpr_kernarg_segment_ptr 1
  .amdhsa_system_sgpr_workgroup_id_x 1
  .amdhsa_float_denorm_mode_32 3
.end_amdhsa_kernel
```
